```python
import torch

def _softmax(x, axis=-1):
    return torch.softmax(x, dim=axis)
def _gelu(x):
    return torch.nn.functional.gelu(x, approximate="tanh")
def _silu(x):
    return torch.nn.functional.silu(x)
def _sigmoid(x):
    return torch.sigmoid(x)
def _layernorm(x, axis=-1, eps=1e-5):
    m = x.mean(dim=axis, keepdim=True)
    v = x.var(dim=axis, keepdim=True, unbiased=False)
    return (x - m) / torch.sqrt(v + eps)
def _scatter_add(tgt, idx, src, axis=0):
    return tgt.clone().index_add_(axis, idx, src)
def _segment_sum(src, seg, n):
    out = torch.zeros((n,) + src.shape[1:], dtype=src.dtype)
    return out.index_add_(0, seg, src)
def _pad(x, pw):
    flat = tuple(v for pair in reversed(pw) for v in pair)
    return torch.nn.functional.pad(x, flat)

kernel_name = 'standalone__sequential_behavior_din__recsys'

def setup_inputs():

    _w = (lambda a: (lambda t: t.to(torch.bfloat16) if t.is_floating_point() else t)(torch.as_tensor(a)))
    B, L, D = 4096, 20, 128
    H = D
    return {
        "target": _w((lambda *s: torch.randn(*s, dtype=torch.bfloat16) * 1.6)(B, D)),
        "hist": _w((lambda *s: torch.randn(*s, dtype=torch.bfloat16) * 1.6)(B, L, D)),
        "mask": _w((lambda lo, hi, *s: torch.randint(lo, hi, s))(0, 2, B, L).to(float)),
        "w1": _w((lambda *s: torch.randn(*s, dtype=torch.bfloat16) * 1.6)(4 * D, H) * (4 * D) ** -0.5),
        "b1": _w((lambda *s: torch.randn(*s, dtype=torch.bfloat16) * 6.4)(H) * 0.1),
        "w2": _w((lambda *s: torch.randn(*s, dtype=torch.bfloat16) * 0.05)(H, 1) * H ** -0.5),
        "b2": _w((lambda *s: torch.randn(*s, dtype=torch.bfloat16) * 0.2)(1) * 0.1),
    }

def reference(target, hist, mask, w1, b1, w2, b2):
    L = hist.shape[1]
    tgt = (lambda x, n, axis: torch.repeat_interleave(x, n, dim=axis))(target[:, None, :], L, axis=1)
    feat = torch.concatenate([hist, tgt, hist - tgt, hist * tgt], axis=-1)
    h = _sigmoid(feat @ w1 + b1)
    scores = (h @ w2 + b2)[..., 0] * mask
    return torch.einsum('bl,bld->bd', scores, hist)
```

```asm
; @launch grid=(256,1,1) block=(512,1,1) lds=163584
.amdgcn_target "amdgcn-amd-amdhsa--gfx950"
.text
.globl standalone__sequential_behavior_din__recsys_kernel
.p2align 12
.fill 832, 4, 0xBF800000
.p2align 8
.type standalone__sequential_behavior_din__recsys_kernel,@function
standalone__sequential_behavior_din__recsys_kernel:
    s_load_dwordx16 s[4:19], s[0:1], 0
    s_getpc_b64 s[60:61]
L_pc:
    s_cmpk_ge_u32 s2, 256
    s_cbranch_scc1 L_end
    v_lshrrev_b32 v12, 6, v0
    v_and_b32 v1, 63, v0
    v_readfirstlane_b32 s3, v12
    v_and_b32 v2, 15, v0
    s_lshr_b32 s43, s2, 3
    s_cmp_lg_u32 s3, 7
    s_cbranch_scc1 L_nopf
    s_lshl_b32 s44, s43, 10
    v_lshl_add_u32 v12, v1, 4, s44
    v_min_u32 v12, ((L_end-L_pc)&0xffff0)-1040, v12
    s_and_b32 s60, s60, 0xffffff00
    v_add_co_u32 v12, vcc, s60, v12
    v_mov_b32 v13, s61
    s_nop 0
    v_addc_co_u32 v13, vcc, 0, v13, vcc
    global_load_dwordx4 v[252:255], v[12:13], off offset:1024
L_nopf:
    s_and_b32 s29, s3, 3
    v_lshrrev_b32 v5, 5, v1
    v_and_b32 v7, 3, v0
    v_lshlrev_b32 v12, 1, v5
    v_xor_b32 v12, v12, v7
    v_lshrrev_b32 v13, 2, v1
    v_lshlrev_b32 v13, 8, v13
    v_lshl_add_u32 v12, v12, 4, v13
    s_lshl_b32 s44, s29, 6
    v_add_u32 v10, s44, v12
    s_lshl_b32 s31, s29, 14
    s_addk_i32 s31, 32512
    s_mov_b32 s27, 0x20000
    s_mov_b32 s26, s27
    v_lshrrev_b32 v3, 4, v1
    v_and_b32 v4, 31, v0
    v_lshrrev_b32 v6, 2, v2
    v_mov_b32 v8, 0
    s_mov_b32 s46, 0xffff0000
    s_mov_b32 s47, 3216550459
    s_cmp_ge_u32 s3, 4
    s_cbranch_scc1 L_main
    s_setprio 2
    s_mul_i32 s42, s2, 640
    v_min_u32 v14, 39, v1
    v_lshl_add_u32 v14, v14, 4, s42
    v_lshrrev_b32 v13, 4, v0
    v_xor_b32 v20, v13, v2
    v_lshlrev_b32 v20, 4, v20
    v_lshl_add_u32 v12, v13, 8, v20
    v_lshl_add_u32 v65, s2, 12, v12
    v_lshl_add_u32 v66, s43, 12, v12
    s_lshl_b32 s57, s29, 10
    s_add_u32 s44, s57, 8704
    s_movk_i32 m0, 18944
    v_lshl_add_u32 v15, v2, 4, v13
    v_lshlrev_b32 v21, 1, v15
    v_lshlrev_b32 v36, 4, v0
    v_add_u32 v37, 98048, v36
    v_lshlrev_b32 v32, 1, v7
    v_lshlrev_b32_e64 v22, 1, s29
    s_add_u32 s57, s57, 48896
    s_mul_i32 s28, s2, 81920
    s_mov_b32 s22, 20971520
    s_mov_b32 s23, s27
    s_mov_b32 s56, 0x40000
    s_waitcnt lgkmcnt(0)
    global_load_lds_dwordx4 v14, s[8:9]
    s_mov_b32 m0, s44
    v_lshlrev_b32 v188, 4, v7
    v_lshlrev_b64 v[190:191], v188, 1
    v_mul_u32_u24 v248, 16223, v190
    v_mul_u32_u24 v249, 16223, v191
    v_mul_u32_u24 v250, 49108, v190
    v_mul_u32_u24 v251, 49108, v191
    v_add_u32 v254, 48896, v36
    v_lshl_add_u32 v189, v3, 2, v6
    v_lshlrev_b32 v189, 1, v189
    v_lshrrev_b32 v188, 1, v7
    global_load_dwordx4 v[68:71], v66, s[10:11]
    global_load_lds_dwordx4 v65, s[4:5] nt
    s_branch L_h2
L_main:
    s_setprio 1
    v_mov_b32 v160, 0
    v_mov_b32 v161, 0
    v_mov_b32 v162, 0
    v_mov_b32 v163, 0
    v_mov_b32 v164, -1
    v_bfe_u32 v165, v0, 2, 4
    v_min_u32 v165, 9, v165
    v_lshlrev_b32 v165, 9, v165
    v_lshl_add_u32 v165, v7, 2, v165
    v_lshlrev_b32 v13, 2, v0
    v_lshlrev_b32 v12, 4, v0
    ds_write_b32 v13, v164 offset:16896
    ds_write_b32 v165, v164 offset:12800
    ds_write_b128 v12, v[160:163] offset:17920
    ds_write_b128 v12, v[160:163] offset:22016
    ds_write_b128 v12, v[160:163] offset:24320
    s_lshl_b32 s51, s29, 6
    v_and_b32 v13, 1, v6
    v_lshlrev_b32 v12, 9, v6
    v_lshl_add_u32 v12, v13, 5, v12
    v_lshl_add_u32 v28, v3, 3, s51
    v_lshl_add_u32 v16, v13, 8, v28
    v_xor_b32 v17, 256, v16
    v_lshl_add_u32 v12, v7, 6, v12
    v_and_b32 v13, 1, v3
    v_lshl_add_u32 v12, v13, 4, v12
    v_lshl_add_u32 v12, v5, 13, v12
    v_add_u32 v14, s31, v12
    v_xor_b32 v15, 32, v14
    v_lshlrev_b32 v13, 2, v13
    v_lshrrev_b32 v12, 1, v2
    v_sub_u32 v13, v12, v13
    v_and_b32 v12, 1, v0
    v_lshlrev_b32 v12, 4, v12
    v_mov_b32 v248, 49081
    v_mov_b32 v249, 15148
    v_lshlrev_b32 v248, v12, v248
    v_lshlrev_b32 v249, v12, v249
    v_cmp_eq_u32 s[32:33], 0, v13
    v_cmp_eq_u32 s[34:35], 1, v13
    v_cmp_eq_u32 s[36:37], 2, v13
    v_cmp_eq_u32 s[38:39], 3, v13
    v_cndmask_b32 v240, 0, v248, s[32:33]
    v_cndmask_b32 v244, 0, v249, s[32:33]
    v_cndmask_b32 v241, 0, v248, s[34:35]
    v_cndmask_b32 v245, 0, v249, s[34:35]
    s_mov_b32 m0, s31
    s_mov_b32 s45, 0
    s_add_u32 s48, s45, 0x10000
    s_waitcnt lgkmcnt(0)
    s_mov_b32 s24, s10
    s_and_b32 s25, s11, 0xffff
    s_load_dword s49, s[16:17], 0
    s_cmp_gt_u32 s29, 1
    s_cbranch_scc1 L_nosmall
    s_cmp_eq_u32 s29, 0
    s_cselect_b64 s[12:13], s[12:13], s[14:15]
    s_lshl_b32 s44, s29, 8
    s_add_u32 m0, s44, 21504
    v_lshlrev_b32 v221, 2, v1
    global_load_lds_dword v221, s[12:13]
    s_mov_b32 m0, s31
    s_nop 0
L_nosmall:
    buffer_load_dwordx4 v10, s[24:27], s48 offen  lds
    s_addk_i32 m0, 8192
    s_addk_i32 s48, 4096
    v_cndmask_b32 v242, 0, v248, s[36:37]
    v_cndmask_b32 v246, 0, v249, s[36:37]
    v_cndmask_b32 v243, 0, v248, s[38:39]
    v_cndmask_b32 v247, 0, v249, s[38:39]
    buffer_load_dwordx4 v10, s[24:27], s45 offen  lds
    s_addk_i32 m0, -7168
    s_addk_i32 s45, 4096
    v_and_b32 v13, 1, v3
    v_lshl_add_u32 v12, v13, 3, v6
    v_lshlrev_b32 v12, 6, v12
    v_lshl_add_u32 v12, v13, 5, v12
    buffer_load_dwordx4 v10, s[24:27], s48 offen  lds
    s_addk_i32 m0, 8192
    s_addk_i32 s48, 4096
    v_lshl_add_u32 v12, v7, 3, v12
    v_lshl_add_u32 v12, v5, 10, v12
    v_add_u32 v18, s31, v12
    v_xor_b32 v19, 32, v18
    buffer_load_dwordx4 v10, s[24:27], s45 offen  lds
    s_addk_i32 m0, -7168
    s_addk_i32 s45, 4096
    v_mul_u32_u24 v12, 544, v2
    v_lshl_add_u32 v12, v3, 4, v12
    s_lshl_b32 s50, s29, 7
    v_add_u32 v27, s50, v12
    buffer_load_dwordx4 v10, s[24:27], s48 offen  lds
    s_addk_i32 m0, 8192
    s_addk_i32 s48, 4096
    v_xor_b32 v12, v3, v2
    v_lshlrev_b32 v12, 4, v12
    v_lshl_add_u32 v37, v2, 8, v12
    v_xor_b32 v38, 64, v37
    buffer_load_dwordx4 v10, s[24:27], s45 offen  lds
    s_addk_i32 m0, -7168
    s_addk_i32 s45, 4096
    v_xor_b32 v39, 128, v37
    v_xor_b32 v40, 192, v37
    v_add_u32 v29, 32512, v37
    v_add_u32 v30, 32512, v38
    buffer_load_dwordx4 v10, s[24:27], s48 offen  lds
    s_addk_i32 m0, 8192
    s_addk_i32 s48, 4096
    v_add_u32 v31, 32512, v39
    v_add_u32 v32, 32512, v40
    v_add_u32 v33, 98048, v37
    v_add_u32 v34, 98048, v38
    buffer_load_dwordx4 v10, s[24:27], s45 offen  lds
    s_addk_i32 m0, -7168
    s_addk_i32 s45, 4096
    v_add_u32 v35, 98048, v39
    v_add_u32 v36, 98048, v40
    s_add_u32 s50, s50, 16
    v_lshl_add_u32 v21, v3, 4, s50
    buffer_load_dwordx4 v10, s[24:27], s48 offen  lds
    s_addk_i32 m0, 8192
    s_addk_i32 s48, 4096
    v_lshlrev_b32_e64 v26, 1, s29
    v_lshlrev_b32 v20, 1, v2
    s_lshl_b32 s50, s29, 2
    v_lshl_add_u32 v23, v4, 4, s50
    buffer_load_dwordx4 v10, s[24:27], s45 offen  lds
    s_addk_i32 m0, -7168
    s_addk_i32 s45, 4096
    v_mov_b32 v64, 0x3f80
    v_mov_b32 v65, 0
    s_mov_b32 s56, 0x40000
    buffer_load_dwordx4 v10, s[24:27], s48 offen  lds
    s_addk_i32 m0, 8192
    s_addk_i32 s48, 4096
    buffer_load_dwordx4 v10, s[24:27], s45 offen  lds
    s_addk_i32 m0, -7168
    s_addk_i32 s45, 4096
    buffer_load_dwordx4 v10, s[24:27], s48 offen  lds
    s_addk_i32 m0, 8192
    s_addk_i32 s48, 4096
    buffer_load_dwordx4 v10, s[24:27], s45 offen  lds
    s_addk_i32 m0, -7168
    s_addk_i32 s45, 4096
    buffer_load_dwordx4 v10, s[24:27], s48 offen  lds
    s_addk_i32 m0, 8192
    s_addk_i32 s48, 4096
    buffer_load_dwordx4 v10, s[24:27], s45 offen  lds
    s_branch L_m2
L_h2:
    s_mov_b32 s24, s10
    s_and_b32 s25, s11, 0xffff
    s_mov_b32 s20, s6
    s_and_b32 s21, s7, 0xffff
    v_lshl_add_u32 v188, s29, 2, v188
    v_xor_b32 v188, v188, v189
    v_and_b32 v188, 15, v188
    v_lshlrev_b32 v188, 4, v188
    v_lshlrev_b32 v12, 1, v1
    s_waitcnt vmcnt(2)
    ds_read_u16 v60, v12 offset:18944
    ds_read_u16 v61, v12 offset:19072
    ds_read_u16 v62, v12 offset:19200
    ds_read_u16 v63, v12 offset:19328
    ds_read_u16 v64, v12 offset:19456
    s_waitcnt lgkmcnt(4)
    v_cmp_neq_f16 s[32:33], 0, v60
    s_waitcnt lgkmcnt(3)
    v_cmp_neq_f16 s[34:35], 0, v61
    s_waitcnt lgkmcnt(2)
    v_cmp_neq_f16 s[36:37], 0, v62
    s_waitcnt lgkmcnt(1)
    v_cmp_neq_f16 s[38:39], 0, v63
    s_waitcnt lgkmcnt(0)
    v_cmp_neq_f16 s[40:41], 0, v64
    s_bcnt1_i32_b64 s50, s[32:33]
    s_bcnt1_i32_b64 s51, s[34:35]
    s_bcnt1_i32_b64 s52, s[36:37]
    s_bcnt1_i32_b64 s53, s[38:39]
    s_bcnt1_i32_b64 s54, s[40:41]
    s_add_u32 s51, s51, s50
    s_add_u32 s52, s52, s51
    s_add_u32 s53, s53, s52
    s_add_u32 s54, s54, s53
    s_add_u32 s30, s54, 15
    s_lshr_b32 s30, s30, 4
    s_max_u32 s30, s30, 1
    s_lshl_b32 s55, s30, 4
    s_sub_u32 s55, s55, s54
    v_subrev_u32 v180, s55, v15
    v_mov_b32 v182, s32
    v_mov_b32 v183, s33
    v_mov_b32 v184, 0
    v_mov_b32 v181, v180
    v_cmp_gt_u32 s[58:59], s54, v180
    v_cmpx_le_u32 vcc, s50, v180
    v_mov_b32 v182, s34
    v_mov_b32 v183, s35
    v_subrev_u32 v181, s50, v180
    v_mov_b32 v184, 64
    v_cmpx_le_u32 vcc, s51, v180
    v_mov_b32 v182, s36
    v_mov_b32 v183, s37
    v_subrev_u32 v181, s51, v180
    v_mov_b32 v184, 128
    v_cmpx_le_u32 vcc, s52, v180
    v_mov_b32 v182, s38
    v_mov_b32 v183, s39
    v_subrev_u32 v181, s52, v180
    v_mov_b32 v184, 192
    v_cmpx_le_u32 vcc, s53, v180
    v_mov_b32 v182, s40
    v_mov_b32 v183, s41
    v_subrev_u32 v181, s53, v180
    v_mov_b32 v184, 256
    s_mov_b64 exec, -1
    v_bcnt_u32_b32 v185, v182, 0
    v_cmpx_le_u32 vcc, v185, v181
    v_sub_u32 v181, v181, v185
    v_mov_b32 v182, v183
    v_add_u32 v184, 32, v184
    s_mov_b64 exec, -1
    v_and_b32 v185, 65535, v182
    v_bcnt_u32_b32 v185, v185, 0
    v_cmpx_le_u32 vcc, v185, v181
    v_sub_u32 v181, v181, v185
    v_lshrrev_b32 v182, 16, v182
    v_add_u32 v184, 16, v184
    s_mov_b64 exec, -1
    v_and_b32 v185, 255, v182
    v_bcnt_u32_b32 v185, v185, 0
    v_cmpx_le_u32 vcc, v185, v181
    v_sub_u32 v181, v181, v185
    v_lshrrev_b32 v182, 8, v182
    v_add_u32 v184, 8, v184
    s_mov_b64 exec, -1
    v_and_b32 v185, 15, v182
    v_bcnt_u32_b32 v185, v185, 0
    v_cmpx_le_u32 vcc, v185, v181
    v_sub_u32 v181, v181, v185
    v_lshrrev_b32 v182, 4, v182
    v_add_u32 v184, 4, v184
    s_mov_b64 exec, -1
    v_and_b32 v185, 3, v182
    v_bcnt_u32_b32 v185, v185, 0
    v_cmpx_le_u32 vcc, v185, v181
    v_sub_u32 v181, v181, v185
    v_lshrrev_b32 v182, 2, v182
    v_add_u32 v184, 2, v184
    s_mov_b64 exec, -1
    v_and_b32 v185, 1, v182
    v_cmpx_le_u32 vcc, v185, v181
    v_add_u32 v184, 1, v184
    s_mov_b64 exec, -1
    v_mul_u32_u24 v17, 3277, v184
    v_lshl_add_u32 v16, v184, 8, s28
    v_mov_b32 v180, 0x7fffff00
    v_lshrrev_b32 v17, 16, v17
    v_cndmask_b32 v16, v180, v16, s[58:59]
    v_mul_u32_u24 v18, 272, v17
    v_mul_u32_u24 v19, 656, v17
    v_mul_u32_u24 v17, 544, v17
    v_lshl_add_u32 v14, v184, 1, s42
    s_branch L_h3
L_m2:
    s_waitcnt vmcnt(16)
    s_barrier
    s_waitcnt lgkmcnt(0)
    s_waitcnt vmcnt(12)
    ds_read_b128 v[160:163], v14 offset:0
    ds_read_b128 v[164:167], v15 offset:0
    ds_read_b128 v[168:171], v14 offset:256
    ds_read_b128 v[172:175], v15 offset:256
    s_lshl_b32 s49, s49, 16
    s_cmp_eq_u32 s29, 0
    s_cselect_b32 s49, s49, 0
    v_mov_b32 v60, s49
    v_mov_b32 v61, s49
    v_mov_b32 v62, s49
    v_mov_b32 v63, s49
    s_waitcnt lgkmcnt(3)
    v_mfma_f32_16x16x32_bf16 v[208:211], v[160:163], v[240:243], 0
    s_waitcnt vmcnt(8)
    ds_read_b128 v[176:179], v14 offset:2048
    ds_read_b128 v[180:183], v15 offset:2048
    s_waitcnt lgkmcnt(4)
    v_mfma_f32_16x16x32_bf16 v[212:215], v[164:167], v[240:243], 0
    ds_read_b128 v[192:195], v37 offset:8704
    ds_read_b128 v[196:199], v38 offset:8704
    ds_read_b128 v[200:203], v39 offset:8704
    v_mfma_f32_16x16x32_bf16 v[208:211], v[160:163], v[244:247], v[208:211]
    ds_read_b128 v[204:207], v40 offset:8704
    ds_read_b64 v[52:53], v28 offset:21504
    ds_read_b64 v[54:55], v28 offset:21536
    v_mfma_f32_16x16x32_bf16 v[212:215], v[164:167], v[244:247], v[212:215]
    ds_read_b64_tr_b16 v[100:101], v18 offset:0
    ds_read_b64_tr_b16 v[102:103], v18 offset:256
    s_waitcnt lgkmcnt(11)
    v_mfma_f32_16x16x32_bf16 v[216:219], v[168:171], v[240:243], 0
    ds_read_b128 v[184:187], v14 offset:2304
    ds_read_b128 v[188:191], v15 offset:2304
    s_waitcnt lgkmcnt(12)
    v_mfma_f32_16x16x32_bf16 v[220:223], v[172:175], v[240:243], 0
    ds_read_b64 v[44:45], v16 offset:21760
    ds_read_b64 v[46:47], v16 offset:21792
    ds_read_b64 v[48:49], v17 offset:21760
    v_mfma_f32_16x16x32_bf16 v[216:219], v[168:171], v[244:247], v[216:219]
    ds_read_b64 v[50:51], v17 offset:21792
    v_mfma_f32_16x16x32_bf16 v[220:223], v[172:175], v[244:247], v[220:223]
    ds_read_b64_tr_b16 v[104:105], v19 offset:0
    ds_read_b64_tr_b16 v[106:107], v19 offset:256
    s_waitcnt lgkmcnt(14)
    v_mfma_f32_16x16x32_bf16 v[224:227], v[176:179], v[240:243], 0
    s_waitcnt vmcnt(4)
    ds_read_b128 v[160:163], v14 offset:4096
    ds_read_b128 v[164:167], v15 offset:4096
    v_mfma_f32_16x16x32_bf16 v[228:231], v[180:183], v[240:243], 0
    v_cvt_pk_bf16_f32 v68, v208, v209
    v_cvt_pk_bf16_f32 v69, v210, v211
    v_mfma_f32_16x16x32_bf16 v[224:227], v[176:179], v[244:247], v[224:227]
    v_cvt_pk_bf16_f32 v72, v212, v213
    v_cvt_pk_bf16_f32 v73, v214, v215
    v_mfma_f32_16x16x32_bf16 v[228:231], v[180:183], v[244:247], v[228:231]
    ds_read_b64_tr_b16 v[108:109], v18 offset:2048
    ds_read_b64_tr_b16 v[110:111], v18 offset:2304
    s_waitcnt lgkmcnt(11)
    v_mfma_f32_16x16x32_bf16 v[232:235], v[184:187], v[240:243], 0
    ds_read_b128 v[168:171], v14 offset:4352
    ds_read_b128 v[172:175], v15 offset:4352
    s_waitcnt lgkmcnt(12)
    v_mfma_f32_16x16x32_bf16 v[236:239], v[188:191], v[240:243], 0
    v_cvt_pk_bf16_f32 v70, v216, v217
    v_cvt_pk_bf16_f32 v71, v218, v219
    v_mfma_f32_16x16x32_bf16 v[232:235], v[184:187], v[244:247], v[232:235]
    v_cvt_pk_bf16_f32 v74, v220, v221
    v_cvt_pk_bf16_f32 v75, v222, v223
    v_mfma_f32_16x16x32_bf16 v[236:239], v[188:191], v[244:247], v[236:239]
    ds_read_b64_tr_b16 v[112:113], v19 offset:2048
    ds_read_b64_tr_b16 v[114:115], v19 offset:2304
    s_waitcnt lgkmcnt(7)
    v_mfma_f32_16x16x32_bf16 v[208:211], v[160:163], v[240:243], 0
    s_waitcnt vmcnt(0)
    ds_read_b128 v[176:179], v14 offset:6144
    ds_read_b128 v[180:183], v15 offset:6144
    s_waitcnt lgkmcnt(8)
    v_mfma_f32_16x16x32_bf16 v[212:215], v[164:167], v[240:243], 0
    v_cvt_pk_bf16_f32 v76, v224, v225
    v_cvt_pk_bf16_f32 v77, v226, v227
    v_mfma_f32_16x16x32_bf16 v[208:211], v[160:163], v[244:247], v[208:211]
    v_cvt_pk_bf16_f32 v80, v228, v229
    v_cvt_pk_bf16_f32 v81, v230, v231
    v_mfma_f32_16x16x32_bf16 v[212:215], v[164:167], v[244:247], v[212:215]
    ds_read_b64_tr_b16 v[116:117], v18 offset:4096
    ds_read_b64_tr_b16 v[118:119], v18 offset:4352
    s_waitcnt lgkmcnt(7)
    v_mfma_f32_16x16x32_bf16 v[216:219], v[168:171], v[240:243], 0
    ds_read_b128 v[184:187], v14 offset:6400
    ds_read_b128 v[188:191], v15 offset:6400
    s_waitcnt lgkmcnt(8)
    v_mfma_f32_16x16x32_bf16 v[220:223], v[172:175], v[240:243], 0
    v_cvt_pk_bf16_f32 v78, v232, v233
    v_cvt_pk_bf16_f32 v79, v234, v235
    v_mfma_f32_16x16x32_bf16 v[216:219], v[168:171], v[244:247], v[216:219]
    v_cvt_pk_bf16_f32 v82, v236, v237
    v_cvt_pk_bf16_f32 v83, v238, v239
    v_mfma_f32_16x16x32_bf16 v[220:223], v[172:175], v[244:247], v[220:223]
    ds_read_b64_tr_b16 v[120:121], v19 offset:4096
    ds_read_b64_tr_b16 v[122:123], v19 offset:4352
    s_waitcnt lgkmcnt(7)
    v_mfma_f32_16x16x32_bf16 v[224:227], v[176:179], v[240:243], 0
    s_waitcnt lgkmcnt(6)
    v_mfma_f32_16x16x32_bf16 v[228:231], v[180:183], v[240:243], 0
    v_cvt_pk_bf16_f32 v84, v208, v209
    v_cvt_pk_bf16_f32 v85, v210, v211
    v_mfma_f32_16x16x32_bf16 v[224:227], v[176:179], v[244:247], v[224:227]
    v_cvt_pk_bf16_f32 v88, v212, v213
    v_cvt_pk_bf16_f32 v89, v214, v215
    v_mfma_f32_16x16x32_bf16 v[228:231], v[180:183], v[244:247], v[228:231]
    ds_read_b64_tr_b16 v[124:125], v18 offset:6144
    ds_read_b64_tr_b16 v[126:127], v18 offset:6400
    s_waitcnt lgkmcnt(5)
    v_mfma_f32_16x16x32_bf16 v[232:235], v[184:187], v[240:243], 0
    s_waitcnt lgkmcnt(4)
    v_mfma_f32_16x16x32_bf16 v[236:239], v[188:191], v[240:243], 0
    v_cvt_pk_bf16_f32 v86, v216, v217
    v_cvt_pk_bf16_f32 v87, v218, v219
    v_mfma_f32_16x16x32_bf16 v[232:235], v[184:187], v[244:247], v[232:235]
    v_cvt_pk_bf16_f32 v90, v220, v221
    v_cvt_pk_bf16_f32 v91, v222, v223
    v_mfma_f32_16x16x32_bf16 v[236:239], v[188:191], v[244:247], v[236:239]
    ds_read_b64_tr_b16 v[128:129], v19 offset:6144
    ds_read_b64_tr_b16 v[130:131], v19 offset:6400
    v_mfma_f32_16x16x32_bf16 v[140:143], v[100:103], v[192:195], 0
    v_cvt_pk_bf16_f32 v92, v224, v225
    v_cvt_pk_bf16_f32 v93, v226, v227
    v_mfma_f32_16x16x32_bf16 v[144:147], v[104:107], v[192:195], 0
    v_cvt_pk_bf16_f32 v96, v228, v229
    v_cvt_pk_bf16_f32 v97, v230, v231
    v_mfma_f32_16x16x32_bf16 v[140:143], v[108:111], v[196:199], v[140:143]
    v_cvt_pk_bf16_f32 v94, v232, v233
    v_cvt_pk_bf16_f32 v95, v234, v235
    v_mfma_f32_16x16x32_bf16 v[144:147], v[112:115], v[196:199], v[144:147]
    v_cvt_pk_bf16_f32 v98, v236, v237
    v_cvt_pk_bf16_f32 v99, v238, v239
    v_mfma_f32_16x16x32_bf16 v[140:143], v[116:119], v[200:203], v[140:143]
    v_lshlrev_b32 v132, 16, v52
    v_and_b32 v133, 0xffff0000, v52
    s_waitcnt lgkmcnt(4)
    v_mfma_f32_16x16x32_bf16 v[144:147], v[120:123], v[200:203], v[144:147]
    v_lshlrev_b32 v134, 16, v53
    v_and_b32 v135, 0xffff0000, v53
    s_waitcnt lgkmcnt(2)
    v_mfma_f32_16x16x32_bf16 v[140:143], v[124:127], v[204:207], v[140:143]
    v_lshlrev_b32 v136, 16, v54
    v_and_b32 v137, 0xffff0000, v54
    s_waitcnt lgkmcnt(0)
    v_mfma_f32_16x16x32_bf16 v[144:147], v[128:131], v[204:207], v[144:147]
    v_lshlrev_b32 v138, 16, v55
    v_and_b32 v139, 0xffff0000, v55
    v_add_u32 v18, 0x10000, v18
    v_add_u32 v19, 0x10000, v19
    s_barrier
    ds_read_b64_tr_b16 v[160:161], v18 offset:0
    ds_read_b64_tr_b16 v[162:163], v18 offset:256
    ds_read_b64_tr_b16 v[164:165], v19 offset:0
    ds_read_b64_tr_b16 v[166:167], v19 offset:256
    ds_read_b64_tr_b16 v[168:169], v18 offset:2048
    ds_read_b64_tr_b16 v[170:171], v18 offset:2304
    ds_read_b64_tr_b16 v[172:173], v19 offset:2048
    ds_read_b64_tr_b16 v[174:175], v19 offset:2304
    ds_read_b64_tr_b16 v[176:177], v18 offset:4096
    ds_read_b64_tr_b16 v[178:179], v18 offset:4352
    ds_read_b64_tr_b16 v[180:181], v19 offset:4096
    ds_read_b64_tr_b16 v[182:183], v19 offset:4352
    ds_read_b64_tr_b16 v[184:185], v18 offset:6144
    ds_read_b64_tr_b16 v[186:187], v18 offset:6400
    ds_read_b64_tr_b16 v[188:189], v19 offset:6144
    ds_read_b64_tr_b16 v[190:191], v19 offset:6400
    s_waitcnt lgkmcnt(14)
    v_mfma_f32_16x16x32_bf16 v[132:135], v[160:163], v[192:195], v[132:135]
    s_waitcnt lgkmcnt(12)
    v_mfma_f32_16x16x32_bf16 v[136:139], v[164:167], v[192:195], v[136:139]
    s_waitcnt lgkmcnt(10)
    v_mfma_f32_16x16x32_bf16 v[132:135], v[168:171], v[196:199], v[132:135]
    s_waitcnt lgkmcnt(8)
    v_mfma_f32_16x16x32_bf16 v[136:139], v[172:175], v[196:199], v[136:139]
    s_waitcnt lgkmcnt(6)
    v_mfma_f32_16x16x32_bf16 v[132:135], v[176:179], v[200:203], v[132:135]
    s_waitcnt lgkmcnt(4)
    v_mfma_f32_16x16x32_bf16 v[136:139], v[180:183], v[200:203], v[136:139]
    s_waitcnt lgkmcnt(2)
    v_mfma_f32_16x16x32_bf16 v[132:135], v[184:187], v[204:207], v[132:135]
    s_waitcnt lgkmcnt(0)
    v_mfma_f32_16x16x32_bf16 v[136:139], v[188:191], v[204:207], v[136:139]
    s_nop 5
    v_sub_f32 v132, v132, v140
    v_sub_f32 v133, v133, v141
    v_sub_f32 v134, v134, v142
    v_sub_f32 v135, v135, v143
    v_sub_f32 v136, v136, v144
    v_sub_f32 v137, v137, v145
    v_sub_f32 v138, v138, v146
    v_sub_f32 v139, v139, v147
    v_mul_f32 v132, s47, v132
    v_mul_f32 v133, s47, v133
    v_mul_f32 v134, s47, v134
    v_mul_f32 v135, s47, v135
    v_mul_f32 v136, s47, v136
    v_mul_f32 v137, s47, v137
    v_mul_f32 v138, s47, v138
    v_mul_f32 v139, s47, v139
    s_barrier
    ds_read_b64_tr_b16 v[100:101], v18 offset:8192
    ds_read_b64_tr_b16 v[102:103], v18 offset:8448
    ds_read_b64_tr_b16 v[104:105], v19 offset:8192
    ds_read_b64_tr_b16 v[106:107], v19 offset:8448
    ds_read_b64_tr_b16 v[108:109], v18 offset:10240
    ds_read_b64_tr_b16 v[110:111], v18 offset:10496
    ds_read_b64_tr_b16 v[112:113], v19 offset:10240
    ds_read_b64_tr_b16 v[114:115], v19 offset:10496
    ds_read_b64_tr_b16 v[116:117], v18 offset:12288
    ds_read_b64_tr_b16 v[118:119], v18 offset:12544
    ds_read_b64_tr_b16 v[120:121], v19 offset:12288
    ds_read_b64_tr_b16 v[122:123], v19 offset:12544
    ds_read_b64_tr_b16 v[124:125], v18 offset:14336
    ds_read_b64_tr_b16 v[126:127], v18 offset:14592
    ds_read_b64_tr_b16 v[128:129], v19 offset:14336
    ds_read_b64_tr_b16 v[130:131], v19 offset:14592
    ds_write_b128 v27, v[132:135] offset:16
    ds_write_b128 v27, v[136:139] offset:80
    ds_write_b16 v26, v8 offset:18560
L_wait0:
    ds_read_i16 v25, v20 offset:17920
    s_sub_u32 s56, s56, 1
    s_cbranch_scc1 L_exit
    s_waitcnt lgkmcnt(0)
    v_add_co_u32 v22, vcc, v25, v21
    s_cbranch_vccnz L_wait0
    ds_read_b128 v[132:135], v22 offset:0
    ds_read_b128 v[160:163], v29 offset:16384
    ds_read_b128 v[136:139], v22 offset:64
    ds_read_b128 v[164:167], v30 offset:16384
    ds_read_b128 v[168:171], v31 offset:16384
    ds_read_b128 v[172:175], v32 offset:16384
    s_waitcnt lgkmcnt(4)
    v_mfma_f32_16x16x32_bf16 v[132:135], v[68:71], v[160:163], v[132:135]
    s_waitcnt lgkmcnt(3)
    ds_read_b128 v[176:179], v29 offset:0
    v_mfma_f32_16x16x32_bf16 v[136:139], v[72:75], v[160:163], v[136:139]
    s_waitcnt lgkmcnt(3)
    ds_read_u16 v13, v26 offset:18576
    v_mfma_f32_16x16x32_bf16 v[132:135], v[76:79], v[164:167], v[132:135]
    ds_read_b128 v[180:183], v30 offset:0
    v_mfma_f32_16x16x32_bf16 v[136:139], v[80:83], v[164:167], v[136:139]
    s_waitcnt lgkmcnt(4)
    v_mfma_f32_16x16x32_bf16 v[132:135], v[84:87], v[168:171], v[132:135]
    ds_read_b128 v[184:187], v31 offset:0
    v_mfma_f32_16x16x32_bf16 v[136:139], v[88:91], v[168:171], v[136:139]
    s_waitcnt lgkmcnt(4)
    v_mfma_f32_16x16x32_bf16 v[132:135], v[92:95], v[172:175], v[132:135]
    ds_read_b128 v[188:191], v32 offset:0
    v_mfma_f32_16x16x32_bf16 v[136:139], v[96:99], v[172:175], v[136:139]
    s_waitcnt lgkmcnt(4)
    s_waitcnt lgkmcnt(3)
    v_readfirstlane_b32 s30, v13
    v_add_u32 v13, 1, v13
    v_lshrrev_b32 v13, 1, v13
    v_lshl_add_u32 v24, v13, 9, v23
    v_mfma_f32_16x16x32_bf16 v[132:135], v[100:103], v[176:179], v[132:135]
    v_mfma_f32_16x16x32_bf16 v[136:139], v[104:107], v[176:179], v[136:139]
    s_waitcnt lgkmcnt(2)
    v_mfma_f32_16x16x32_bf16 v[132:135], v[108:111], v[180:183], v[132:135]
    v_mfma_f32_16x16x32_bf16 v[136:139], v[112:115], v[180:183], v[136:139]
    s_waitcnt lgkmcnt(1)
    v_mfma_f32_16x16x32_bf16 v[132:135], v[116:119], v[184:187], v[132:135]
    v_mfma_f32_16x16x32_bf16 v[136:139], v[120:123], v[184:187], v[136:139]
    s_waitcnt lgkmcnt(0)
    v_mfma_f32_16x16x32_bf16 v[132:135], v[124:127], v[188:191], v[132:135]
    v_mfma_f32_16x16x32_bf16 v[136:139], v[128:131], v[188:191], v[136:139]
    ds_read_i16 v25, v20 offset:17952
    s_nop 5
    v_exp_f32 v148, v132
    v_exp_f32 v149, v133
    v_exp_f32 v150, v134
    v_exp_f32 v151, v135
    v_exp_f32 v152, v136
    v_exp_f32 v153, v137
    v_mfma_f32_4x4x4_16b_bf16 v[148:151], v[64:65], v[64:65], v[148:151]
    v_exp_f32 v154, v138
    v_exp_f32 v155, v139
    s_waitcnt lgkmcnt(0)
    v_add_co_u32 v22, vcc, v25, v21
    s_nop 1
    v_mfma_f32_4x4x4_16b_bf16 v[152:155], v[64:65], v[64:65], v[152:155]
    v_rcp_f32 v148, v148
    s_cbranch_vccz L_back0
    s_branch L_slow0
.p2align 12
L_back0:
    ds_read_b128 v[140:143], v22 offset:0
    ds_read_b128 v[160:163], v29 offset:20480
    ds_read_b128 v[144:147], v22 offset:64
    ds_read_b128 v[164:167], v30 offset:20480
    ds_read_b128 v[168:171], v31 offset:20480
    ds_read_b128 v[172:175], v32 offset:20480
    v_rcp_f32 v149, v149
    v_rcp_f32 v150, v150
    v_rcp_f32 v151, v151
    v_cvt_pk_bf16_f32 v156, v148, v149
    v_rcp_f32 v152, v152
    v_rcp_f32 v153, v153
    v_cvt_pk_bf16_f32 v157, v150, v151
    v_rcp_f32 v154, v154
    v_rcp_f32 v155, v155
    v_cvt_pk_bf16_f32 v158, v152, v153
    v_cvt_pk_bf16_f32 v159, v154, v155
    s_waitcnt lgkmcnt(4)
    v_mfma_f32_16x16x32_bf16 v[140:143], v[68:71], v[160:163], v[140:143]
    s_waitcnt lgkmcnt(3)
    ds_read_b128 v[176:179], v29 offset:4096
    v_mfma_f32_16x16x32_bf16 v[144:147], v[72:75], v[160:163], v[144:147]
    s_waitcnt lgkmcnt(3)
    v_mfma_f32_16x16x32_bf16 v[140:143], v[76:79], v[164:167], v[140:143]
    ds_read_b128 v[180:183], v30 offset:4096
    v_mfma_f32_16x16x32_bf16 v[144:147], v[80:83], v[164:167], v[144:147]
    s_waitcnt lgkmcnt(3)
    v_mfma_f32_16x16x32_bf16 v[140:143], v[84:87], v[168:171], v[140:143]
    ds_read_b128 v[184:187], v31 offset:4096
    v_mfma_f32_16x16x32_bf16 v[144:147], v[88:91], v[168:171], v[144:147]
    s_waitcnt lgkmcnt(3)
    ds_read_i16 v25, v20 offset:17984
    v_mfma_f32_16x16x32_bf16 v[140:143], v[92:95], v[172:175], v[140:143]
    ds_read_b128 v[188:191], v32 offset:4096
    v_mfma_f32_16x16x32_bf16 v[144:147], v[96:99], v[172:175], v[144:147]
    s_waitcnt lgkmcnt(4)
    v_mfma_f32_16x16x32_bf16 v[140:143], v[100:103], v[176:179], v[140:143]
    v_mfma_f32_16x16x32_bf16 v[144:147], v[104:107], v[176:179], v[144:147]
    s_waitcnt lgkmcnt(1)
    v_add_co_u32 v22, vcc, v25, v21
    v_mfma_f32_16x16x32_bf16 v[140:143], v[108:111], v[180:183], v[140:143]
    v_mfma_f32_16x16x32_bf16 v[144:147], v[112:115], v[180:183], v[144:147]
    s_cbranch_vccnz L_slow1
L_back1:
    v_mfma_f32_16x16x32_bf16 v[140:143], v[116:119], v[184:187], v[140:143]
    ds_read_b128 v[132:135], v22 offset:0
    ds_read_b128 v[160:163], v29 offset:24576
    v_mfma_f32_16x16x32_bf16 v[144:147], v[120:123], v[184:187], v[144:147]
    s_waitcnt lgkmcnt(2)
    ds_read_b128 v[136:139], v22 offset:64
    ds_read_b128 v[164:167], v30 offset:24576
    v_mfma_f32_16x16x32_bf16 v[140:143], v[124:127], v[188:191], v[140:143]
    ds_read_b128 v[168:171], v31 offset:24576
    ds_read_b128 v[172:175], v32 offset:24576
    v_mfma_f32_16x16x32_bf16 v[144:147], v[128:131], v[188:191], v[144:147]
    s_waitcnt lgkmcnt(4)
    v_mfma_f32_16x16x32_bf16 v[132:135], v[68:71], v[160:163], v[132:135]
    s_waitcnt lgkmcnt(3)
    ds_read_b128 v[176:179], v29 offset:8192
    s_nop 0
    v_exp_f32 v148, v140
    v_mfma_f32_16x16x32_bf16 v[52:55], v[44:47], v[156:159], v[60:63]
    v_exp_f32 v149, v141
    v_mfma_f32_16x16x32_bf16 v[136:139], v[72:75], v[160:163], v[136:139]
    s_waitcnt lgkmcnt(3)
    ds_read_i16 v25, v20 offset:18016
    v_exp_f32 v150, v142
    v_mfma_f32_16x16x32_bf16 v[132:135], v[76:79], v[164:167], v[132:135]
    ds_read_b128 v[180:183], v30 offset:8192
    v_exp_f32 v151, v143
    v_mfma_f32_16x16x32_bf16 v[136:139], v[80:83], v[164:167], v[136:139]
    s_waitcnt lgkmcnt(4)
    v_exp_f32 v152, v144
    v_mfma_f32_16x16x32_bf16 v[132:135], v[84:87], v[168:171], v[132:135]
    ds_read_b128 v[184:187], v31 offset:8192
    v_exp_f32 v153, v145
    v_mfma_f32_4x4x4_16b_bf16 v[148:151], v[64:65], v[64:65], v[148:151]
    v_exp_f32 v154, v146
    v_mfma_f32_16x16x32_bf16 v[136:139], v[88:91], v[168:171], v[136:139]
    s_waitcnt lgkmcnt(2)
    v_add_co_u32 v22, vcc, v25, v21
    v_exp_f32 v155, v147
    v_mfma_f32_16x16x32_bf16 v[132:135], v[92:95], v[172:175], v[132:135]
    ds_read_b128 v[188:191], v32 offset:8192
    v_rcp_f32 v148, v148
    v_mfma_f32_16x16x32_bf16 v[136:139], v[96:99], v[172:175], v[136:139]
    v_rcp_f32 v149, v149
    s_cbranch_vccnz L_slow2
L_back2:
    v_mfma_f32_16x16x32_bf16 v[132:135], v[100:103], v[176:179], v[132:135]
    ds_read_b128 v[140:143], v22 offset:0
    v_rcp_f32 v150, v150
    v_mfma_f32_4x4x4_16b_bf16 v[152:155], v[64:65], v[64:65], v[152:155]
    v_rcp_f32 v151, v151
    v_mfma_f32_16x16x32_bf16 v[136:139], v[104:107], v[176:179], v[136:139]
    s_waitcnt lgkmcnt(3)
    ds_read_b128 v[160:163], v29 offset:28672
    v_cvt_pk_bf16_f32 v156, v148, v149
    v_mfma_f32_16x16x32_bf16 v[132:135], v[108:111], v[180:183], v[132:135]
    ds_read_b128 v[144:147], v22 offset:64
    v_cvt_pk_bf16_f32 v157, v150, v151
    v_mfma_f32_16x16x32_bf16 v[136:139], v[112:115], v[180:183], v[136:139]
    s_waitcnt lgkmcnt(4)
    ds_read_b128 v[164:167], v30 offset:28672
    v_rcp_f32 v152, v152
    v_mfma_f32_16x16x32_bf16 v[132:135], v[116:119], v[184:187], v[132:135]
    ds_read_b128 v[168:171], v31 offset:28672
    v_rcp_f32 v153, v153
    v_mfma_f32_16x16x32_bf16 v[136:139], v[120:123], v[184:187], v[136:139]
    s_waitcnt lgkmcnt(5)
    ds_read_b128 v[172:175], v32 offset:28672
    v_rcp_f32 v154, v154
    v_mfma_f32_16x16x32_bf16 v[132:135], v[124:127], v[188:191], v[132:135]
    v_rcp_f32 v155, v155
    v_mfma_f32_16x16x32_bf16 v[136:139], v[128:131], v[188:191], v[136:139]
    s_waitcnt lgkmcnt(4)
    v_cvt_pk_bf16_f32 v158, v152, v153
    v_cvt_pk_bf16_f32 v159, v154, v155
    v_mfma_f32_16x16x32_bf16 v[140:143], v[68:71], v[160:163], v[140:143]
    s_waitcnt lgkmcnt(3)
    ds_read_b128 v[176:179], v29 offset:12288
    v_exp_f32 v148, v132
    v_mfma_f32_16x16x32_bf16 v[52:55], v[48:51], v[156:159], v[52:55]
    v_exp_f32 v149, v133
    v_mfma_f32_16x16x32_bf16 v[144:147], v[72:75], v[160:163], v[144:147]
    s_waitcnt lgkmcnt(3)
    ds_read_i16 v25, v20 offset:18048
    v_exp_f32 v150, v134
    v_mfma_f32_16x16x32_bf16 v[140:143], v[76:79], v[164:167], v[140:143]
    ds_read_b128 v[180:183], v30 offset:12288
    v_exp_f32 v151, v135
    v_mfma_f32_16x16x32_bf16 v[144:147], v[80:83], v[164:167], v[144:147]
    s_waitcnt lgkmcnt(4)
    v_exp_f32 v152, v136
    v_mfma_f32_16x16x32_bf16 v[140:143], v[84:87], v[168:171], v[140:143]
    ds_read_b128 v[184:187], v31 offset:12288
    v_exp_f32 v153, v137
    v_mfma_f32_4x4x4_16b_bf16 v[148:151], v[64:65], v[64:65], v[148:151]
    v_exp_f32 v154, v138
    v_mfma_f32_16x16x32_bf16 v[144:147], v[88:91], v[168:171], v[144:147]
    s_waitcnt lgkmcnt(2)
    ds_write_b32 v23, v52 offset:12800
    v_add_co_u32 v22, vcc, v25, v21
    v_exp_f32 v155, v139
    v_mfma_f32_16x16x32_bf16 v[140:143], v[92:95], v[172:175], v[140:143]
    ds_read_b128 v[188:191], v32 offset:12288
    v_rcp_f32 v148, v148
    v_mfma_f32_16x16x32_bf16 v[144:147], v[96:99], v[172:175], v[144:147]
    v_rcp_f32 v149, v149
    s_cbranch_vccnz L_slow3
L_back3:
    v_mfma_f32_16x16x32_bf16 v[140:143], v[100:103], v[176:179], v[140:143]
    ds_read_b128 v[132:135], v22 offset:0
    v_rcp_f32 v150, v150
    v_mfma_f32_4x4x4_16b_bf16 v[152:155], v[64:65], v[64:65], v[152:155]
    v_rcp_f32 v151, v151
    v_mfma_f32_16x16x32_bf16 v[144:147], v[104:107], v[176:179], v[144:147]
    s_waitcnt lgkmcnt(4)
    ds_read_b128 v[160:163], v29 offset:32768
    v_cvt_pk_bf16_f32 v156, v148, v149
    v_mfma_f32_16x16x32_bf16 v[140:143], v[108:111], v[180:183], v[140:143]
    ds_read_b128 v[136:139], v22 offset:64
    v_cvt_pk_bf16_f32 v157, v150, v151
    v_mfma_f32_16x16x32_bf16 v[144:147], v[112:115], v[180:183], v[144:147]
    s_waitcnt lgkmcnt(5)
    ds_read_b128 v[164:167], v30 offset:32768
    v_rcp_f32 v152, v152
    v_mfma_f32_16x16x32_bf16 v[140:143], v[116:119], v[184:187], v[140:143]
    ds_read_b128 v[168:171], v31 offset:32768
    v_rcp_f32 v153, v153
    v_mfma_f32_16x16x32_bf16 v[144:147], v[120:123], v[184:187], v[144:147]
    s_waitcnt lgkmcnt(5)
    ds_read_b128 v[172:175], v32 offset:32768
    v_rcp_f32 v154, v154
    v_mfma_f32_16x16x32_bf16 v[140:143], v[124:127], v[188:191], v[140:143]
    v_rcp_f32 v155, v155
    v_mfma_f32_16x16x32_bf16 v[144:147], v[128:131], v[188:191], v[144:147]
    s_waitcnt lgkmcnt(4)
    v_cvt_pk_bf16_f32 v158, v152, v153
    v_cvt_pk_bf16_f32 v159, v154, v155
    v_mfma_f32_16x16x32_bf16 v[132:135], v[68:71], v[160:163], v[132:135]
    s_waitcnt lgkmcnt(3)
    ds_read_b128 v[176:179], v33 offset:8192
    v_exp_f32 v148, v140
    v_mfma_f32_16x16x32_bf16 v[52:55], v[44:47], v[156:159], v[60:63]
    v_exp_f32 v149, v141
    v_mfma_f32_16x16x32_bf16 v[136:139], v[72:75], v[160:163], v[136:139]
    s_waitcnt lgkmcnt(3)
    ds_read_i16 v25, v20 offset:18080
    v_exp_f32 v150, v142
    v_mfma_f32_16x16x32_bf16 v[132:135], v[76:79], v[164:167], v[132:135]
    ds_read_b128 v[180:183], v34 offset:8192
    v_exp_f32 v151, v143
    v_mfma_f32_16x16x32_bf16 v[136:139], v[80:83], v[164:167], v[136:139]
    s_waitcnt lgkmcnt(4)
    v_exp_f32 v152, v144
    v_mfma_f32_16x16x32_bf16 v[132:135], v[84:87], v[168:171], v[132:135]
    ds_read_b128 v[184:187], v35 offset:8192
    v_exp_f32 v153, v145
    v_mfma_f32_4x4x4_16b_bf16 v[148:151], v[64:65], v[64:65], v[148:151]
    v_exp_f32 v154, v146
    v_mfma_f32_16x16x32_bf16 v[136:139], v[88:91], v[168:171], v[136:139]
    s_waitcnt lgkmcnt(2)
    v_add_co_u32 v22, vcc, v25, v21
    v_exp_f32 v155, v147
    v_mfma_f32_16x16x32_bf16 v[132:135], v[92:95], v[172:175], v[132:135]
    ds_read_b128 v[188:191], v36 offset:8192
    v_rcp_f32 v148, v148
    v_mfma_f32_16x16x32_bf16 v[136:139], v[96:99], v[172:175], v[136:139]
    v_rcp_f32 v149, v149
    s_cbranch_vccnz L_slow4
L_back4:
    v_mfma_f32_16x16x32_bf16 v[132:135], v[100:103], v[176:179], v[132:135]
    ds_read_b128 v[140:143], v22 offset:0
    v_rcp_f32 v150, v150
    v_mfma_f32_4x4x4_16b_bf16 v[152:155], v[64:65], v[64:65], v[152:155]
    v_rcp_f32 v151, v151
    v_mfma_f32_16x16x32_bf16 v[136:139], v[104:107], v[176:179], v[136:139]
    s_waitcnt lgkmcnt(3)
    ds_read_b128 v[160:163], v29 offset:36864
    v_cvt_pk_bf16_f32 v156, v148, v149
    v_mfma_f32_16x16x32_bf16 v[132:135], v[108:111], v[180:183], v[132:135]
    ds_read_b128 v[144:147], v22 offset:64
    v_cvt_pk_bf16_f32 v157, v150, v151
    v_mfma_f32_16x16x32_bf16 v[136:139], v[112:115], v[180:183], v[136:139]
    s_waitcnt lgkmcnt(4)
    ds_read_b128 v[164:167], v30 offset:36864
    v_rcp_f32 v152, v152
    v_mfma_f32_16x16x32_bf16 v[132:135], v[116:119], v[184:187], v[132:135]
    ds_read_b128 v[168:171], v31 offset:36864
    v_rcp_f32 v153, v153
    v_mfma_f32_16x16x32_bf16 v[136:139], v[120:123], v[184:187], v[136:139]
    s_waitcnt lgkmcnt(5)
    ds_read_b128 v[172:175], v32 offset:36864
    v_rcp_f32 v154, v154
    v_mfma_f32_16x16x32_bf16 v[132:135], v[124:127], v[188:191], v[132:135]
    v_rcp_f32 v155, v155
    v_mfma_f32_16x16x32_bf16 v[136:139], v[128:131], v[188:191], v[136:139]
    s_waitcnt lgkmcnt(4)
    v_cvt_pk_bf16_f32 v158, v152, v153
    v_cvt_pk_bf16_f32 v159, v154, v155
    v_mfma_f32_16x16x32_bf16 v[140:143], v[68:71], v[160:163], v[140:143]
    s_waitcnt lgkmcnt(3)
    ds_read_b128 v[176:179], v33 offset:12288
    v_exp_f32 v148, v132
    v_mfma_f32_16x16x32_bf16 v[52:55], v[48:51], v[156:159], v[52:55]
    v_exp_f32 v149, v133
    v_mfma_f32_16x16x32_bf16 v[144:147], v[72:75], v[160:163], v[144:147]
    s_waitcnt lgkmcnt(3)
    ds_read_i16 v25, v20 offset:18112
    v_exp_f32 v150, v134
    v_mfma_f32_16x16x32_bf16 v[140:143], v[76:79], v[164:167], v[140:143]
    ds_read_b128 v[180:183], v34 offset:12288
    v_exp_f32 v151, v135
    v_mfma_f32_16x16x32_bf16 v[144:147], v[80:83], v[164:167], v[144:147]
    s_waitcnt lgkmcnt(4)
    v_exp_f32 v152, v136
    v_mfma_f32_16x16x32_bf16 v[140:143], v[84:87], v[168:171], v[140:143]
    ds_read_b128 v[184:187], v35 offset:12288
    v_exp_f32 v153, v137
    v_mfma_f32_4x4x4_16b_bf16 v[148:151], v[64:65], v[64:65], v[148:151]
    v_exp_f32 v154, v138
    v_mfma_f32_16x16x32_bf16 v[144:147], v[88:91], v[168:171], v[144:147]
    s_waitcnt lgkmcnt(2)
    ds_write_b32 v23, v52 offset:13312
    v_add_co_u32 v22, vcc, v25, v21
    v_exp_f32 v155, v139
    v_mfma_f32_16x16x32_bf16 v[140:143], v[92:95], v[172:175], v[140:143]
    ds_read_b128 v[188:191], v36 offset:12288
    v_rcp_f32 v148, v148
    v_mfma_f32_16x16x32_bf16 v[144:147], v[96:99], v[172:175], v[144:147]
    v_rcp_f32 v149, v149
    s_cbranch_vccnz L_slow5
L_back5:
    v_mfma_f32_16x16x32_bf16 v[140:143], v[100:103], v[176:179], v[140:143]
    ds_read_b128 v[132:135], v22 offset:0
    v_rcp_f32 v150, v150
    v_mfma_f32_4x4x4_16b_bf16 v[152:155], v[64:65], v[64:65], v[152:155]
    v_rcp_f32 v151, v151
    v_mfma_f32_16x16x32_bf16 v[144:147], v[104:107], v[176:179], v[144:147]
    s_waitcnt lgkmcnt(4)
    ds_read_b128 v[160:163], v29 offset:40960
    v_cvt_pk_bf16_f32 v156, v148, v149
    v_mfma_f32_16x16x32_bf16 v[140:143], v[108:111], v[180:183], v[140:143]
    ds_read_b128 v[136:139], v22 offset:64
    v_cvt_pk_bf16_f32 v157, v150, v151
    v_mfma_f32_16x16x32_bf16 v[144:147], v[112:115], v[180:183], v[144:147]
    s_waitcnt lgkmcnt(5)
    ds_read_b128 v[164:167], v30 offset:40960
    v_rcp_f32 v152, v152
    v_mfma_f32_16x16x32_bf16 v[140:143], v[116:119], v[184:187], v[140:143]
    ds_read_b128 v[168:171], v31 offset:40960
    v_rcp_f32 v153, v153
    v_mfma_f32_16x16x32_bf16 v[144:147], v[120:123], v[184:187], v[144:147]
    s_waitcnt lgkmcnt(5)
    ds_read_b128 v[172:175], v32 offset:40960
    v_rcp_f32 v154, v154
    v_mfma_f32_16x16x32_bf16 v[140:143], v[124:127], v[188:191], v[140:143]
    v_rcp_f32 v155, v155
    v_mfma_f32_16x16x32_bf16 v[144:147], v[128:131], v[188:191], v[144:147]
    s_waitcnt lgkmcnt(4)
    v_cvt_pk_bf16_f32 v158, v152, v153
    v_cvt_pk_bf16_f32 v159, v154, v155
    v_mfma_f32_16x16x32_bf16 v[132:135], v[68:71], v[160:163], v[132:135]
    s_waitcnt lgkmcnt(3)
    ds_read_b128 v[176:179], v33 offset:16384
    v_exp_f32 v148, v140
    v_mfma_f32_16x16x32_bf16 v[52:55], v[44:47], v[156:159], v[60:63]
    v_exp_f32 v149, v141
    v_mfma_f32_16x16x32_bf16 v[136:139], v[72:75], v[160:163], v[136:139]
    s_waitcnt lgkmcnt(3)
    ds_read_i16 v25, v20 offset:18144
    v_exp_f32 v150, v142
    v_mfma_f32_16x16x32_bf16 v[132:135], v[76:79], v[164:167], v[132:135]
    ds_read_b128 v[180:183], v34 offset:16384
    v_exp_f32 v151, v143
    v_mfma_f32_16x16x32_bf16 v[136:139], v[80:83], v[164:167], v[136:139]
    s_waitcnt lgkmcnt(4)
    v_exp_f32 v152, v144
    v_mfma_f32_16x16x32_bf16 v[132:135], v[84:87], v[168:171], v[132:135]
    ds_read_b128 v[184:187], v35 offset:16384
    v_exp_f32 v153, v145
    v_mfma_f32_4x4x4_16b_bf16 v[148:151], v[64:65], v[64:65], v[148:151]
    v_exp_f32 v154, v146
    v_mfma_f32_16x16x32_bf16 v[136:139], v[88:91], v[168:171], v[136:139]
    s_waitcnt lgkmcnt(2)
    v_add_co_u32 v22, vcc, v25, v21
    v_exp_f32 v155, v147
    v_mfma_f32_16x16x32_bf16 v[132:135], v[92:95], v[172:175], v[132:135]
    ds_read_b128 v[188:191], v36 offset:16384
    v_rcp_f32 v148, v148
    v_mfma_f32_16x16x32_bf16 v[136:139], v[96:99], v[172:175], v[136:139]
    v_rcp_f32 v149, v149
    s_cbranch_vccnz L_slow6
L_back6:
    v_mfma_f32_16x16x32_bf16 v[132:135], v[100:103], v[176:179], v[132:135]
    ds_read_b128 v[140:143], v22 offset:0
    v_rcp_f32 v150, v150
    v_mfma_f32_4x4x4_16b_bf16 v[152:155], v[64:65], v[64:65], v[152:155]
    v_rcp_f32 v151, v151
    v_mfma_f32_16x16x32_bf16 v[136:139], v[104:107], v[176:179], v[136:139]
    s_waitcnt lgkmcnt(3)
    ds_read_b128 v[160:163], v29 offset:45056
    v_cvt_pk_bf16_f32 v156, v148, v149
    v_mfma_f32_16x16x32_bf16 v[132:135], v[108:111], v[180:183], v[132:135]
    ds_read_b128 v[144:147], v22 offset:64
    v_cvt_pk_bf16_f32 v157, v150, v151
    v_mfma_f32_16x16x32_bf16 v[136:139], v[112:115], v[180:183], v[136:139]
    s_waitcnt lgkmcnt(4)
    ds_read_b128 v[164:167], v30 offset:45056
    v_rcp_f32 v152, v152
    v_mfma_f32_16x16x32_bf16 v[132:135], v[116:119], v[184:187], v[132:135]
    ds_read_b128 v[168:171], v31 offset:45056
    v_rcp_f32 v153, v153
    v_mfma_f32_16x16x32_bf16 v[136:139], v[120:123], v[184:187], v[136:139]
    s_waitcnt lgkmcnt(5)
    ds_read_b128 v[172:175], v32 offset:45056
    v_rcp_f32 v154, v154
    v_mfma_f32_16x16x32_bf16 v[132:135], v[124:127], v[188:191], v[132:135]
    v_rcp_f32 v155, v155
    v_mfma_f32_16x16x32_bf16 v[136:139], v[128:131], v[188:191], v[136:139]
    s_waitcnt lgkmcnt(4)
    v_cvt_pk_bf16_f32 v158, v152, v153
    v_cvt_pk_bf16_f32 v159, v154, v155
    v_mfma_f32_16x16x32_bf16 v[140:143], v[68:71], v[160:163], v[140:143]
    s_waitcnt lgkmcnt(3)
    ds_read_b128 v[176:179], v33 offset:20480
    v_exp_f32 v148, v132
    v_mfma_f32_16x16x32_bf16 v[52:55], v[48:51], v[156:159], v[52:55]
    v_exp_f32 v149, v133
    v_mfma_f32_16x16x32_bf16 v[144:147], v[72:75], v[160:163], v[144:147]
    s_waitcnt lgkmcnt(3)
    ds_read_i16 v25, v20 offset:18176
    v_exp_f32 v150, v134
    v_mfma_f32_16x16x32_bf16 v[140:143], v[76:79], v[164:167], v[140:143]
    ds_read_b128 v[180:183], v34 offset:20480
    v_exp_f32 v151, v135
    v_mfma_f32_16x16x32_bf16 v[144:147], v[80:83], v[164:167], v[144:147]
    s_waitcnt lgkmcnt(4)
    v_exp_f32 v152, v136
    v_mfma_f32_16x16x32_bf16 v[140:143], v[84:87], v[168:171], v[140:143]
    ds_read_b128 v[184:187], v35 offset:20480
    v_exp_f32 v153, v137
    v_mfma_f32_4x4x4_16b_bf16 v[148:151], v[64:65], v[64:65], v[148:151]
    v_exp_f32 v154, v138
    v_mfma_f32_16x16x32_bf16 v[144:147], v[88:91], v[168:171], v[144:147]
    s_waitcnt lgkmcnt(2)
    ds_write_b32 v23, v52 offset:13824
    v_add_co_u32 v22, vcc, v25, v21
    v_exp_f32 v155, v139
    v_mfma_f32_16x16x32_bf16 v[140:143], v[92:95], v[172:175], v[140:143]
    ds_read_b128 v[188:191], v36 offset:20480
    v_rcp_f32 v148, v148
    v_mfma_f32_16x16x32_bf16 v[144:147], v[96:99], v[172:175], v[144:147]
    v_rcp_f32 v149, v149
    s_cbranch_vccnz L_slow7
L_back7:
    v_mfma_f32_16x16x32_bf16 v[140:143], v[100:103], v[176:179], v[140:143]
    ds_read_b128 v[132:135], v22 offset:0
    v_rcp_f32 v150, v150
    v_mfma_f32_4x4x4_16b_bf16 v[152:155], v[64:65], v[64:65], v[152:155]
    v_rcp_f32 v151, v151
    v_mfma_f32_16x16x32_bf16 v[144:147], v[104:107], v[176:179], v[144:147]
    s_waitcnt lgkmcnt(4)
    ds_read_b128 v[160:163], v29 offset:49152
    v_cvt_pk_bf16_f32 v156, v148, v149
    v_mfma_f32_16x16x32_bf16 v[140:143], v[108:111], v[180:183], v[140:143]
    ds_read_b128 v[136:139], v22 offset:64
    v_cvt_pk_bf16_f32 v157, v150, v151
    v_mfma_f32_16x16x32_bf16 v[144:147], v[112:115], v[180:183], v[144:147]
    s_waitcnt lgkmcnt(5)
    ds_read_b128 v[164:167], v30 offset:49152
    v_rcp_f32 v152, v152
    v_mfma_f32_16x16x32_bf16 v[140:143], v[116:119], v[184:187], v[140:143]
    ds_read_b128 v[168:171], v31 offset:49152
    v_rcp_f32 v153, v153
    v_mfma_f32_16x16x32_bf16 v[144:147], v[120:123], v[184:187], v[144:147]
    s_waitcnt lgkmcnt(5)
    ds_read_b128 v[172:175], v32 offset:49152
    v_rcp_f32 v154, v154
    v_mfma_f32_16x16x32_bf16 v[140:143], v[124:127], v[188:191], v[140:143]
    v_rcp_f32 v155, v155
    v_mfma_f32_16x16x32_bf16 v[144:147], v[128:131], v[188:191], v[144:147]
    s_waitcnt lgkmcnt(4)
    v_cvt_pk_bf16_f32 v158, v152, v153
    v_cvt_pk_bf16_f32 v159, v154, v155
    v_mfma_f32_16x16x32_bf16 v[132:135], v[68:71], v[160:163], v[132:135]
    s_waitcnt lgkmcnt(3)
    ds_read_b128 v[176:179], v33 offset:24576
    v_exp_f32 v148, v140
    v_mfma_f32_16x16x32_bf16 v[52:55], v[44:47], v[156:159], v[60:63]
    v_exp_f32 v149, v141
    v_mfma_f32_16x16x32_bf16 v[136:139], v[72:75], v[160:163], v[136:139]
    s_waitcnt lgkmcnt(3)
    ds_read_i16 v25, v20 offset:18208
    v_exp_f32 v150, v142
    v_mfma_f32_16x16x32_bf16 v[132:135], v[76:79], v[164:167], v[132:135]
    ds_read_b128 v[180:183], v34 offset:24576
    v_exp_f32 v151, v143
    v_mfma_f32_16x16x32_bf16 v[136:139], v[80:83], v[164:167], v[136:139]
    s_waitcnt lgkmcnt(4)
    v_exp_f32 v152, v144
    v_mfma_f32_16x16x32_bf16 v[132:135], v[84:87], v[168:171], v[132:135]
    ds_read_b128 v[184:187], v35 offset:24576
    v_exp_f32 v153, v145
    v_mfma_f32_4x4x4_16b_bf16 v[148:151], v[64:65], v[64:65], v[148:151]
    v_exp_f32 v154, v146
    v_mfma_f32_16x16x32_bf16 v[136:139], v[88:91], v[168:171], v[136:139]
    s_waitcnt lgkmcnt(2)
    v_add_co_u32 v22, vcc, v25, v21
    v_exp_f32 v155, v147
    v_mfma_f32_16x16x32_bf16 v[132:135], v[92:95], v[172:175], v[132:135]
    ds_read_b128 v[188:191], v36 offset:24576
    v_rcp_f32 v148, v148
    v_mfma_f32_16x16x32_bf16 v[136:139], v[96:99], v[172:175], v[136:139]
    v_rcp_f32 v149, v149
    s_cbranch_vccnz L_slow8
L_back8:
    v_mfma_f32_16x16x32_bf16 v[132:135], v[100:103], v[176:179], v[132:135]
    ds_read_b128 v[140:143], v22 offset:0
    v_rcp_f32 v150, v150
    v_mfma_f32_4x4x4_16b_bf16 v[152:155], v[64:65], v[64:65], v[152:155]
    v_rcp_f32 v151, v151
    v_mfma_f32_16x16x32_bf16 v[136:139], v[104:107], v[176:179], v[136:139]
    s_waitcnt lgkmcnt(3)
    ds_read_b128 v[160:163], v29 offset:53248
    v_cvt_pk_bf16_f32 v156, v148, v149
    v_mfma_f32_16x16x32_bf16 v[132:135], v[108:111], v[180:183], v[132:135]
    ds_read_b128 v[144:147], v22 offset:64
    v_cvt_pk_bf16_f32 v157, v150, v151
    v_mfma_f32_16x16x32_bf16 v[136:139], v[112:115], v[180:183], v[136:139]
    s_waitcnt lgkmcnt(4)
    ds_read_b128 v[164:167], v30 offset:53248
    v_rcp_f32 v152, v152
    v_mfma_f32_16x16x32_bf16 v[132:135], v[116:119], v[184:187], v[132:135]
    ds_read_b128 v[168:171], v31 offset:53248
    v_rcp_f32 v153, v153
    v_mfma_f32_16x16x32_bf16 v[136:139], v[120:123], v[184:187], v[136:139]
    s_waitcnt lgkmcnt(5)
    ds_read_b128 v[172:175], v32 offset:53248
    v_rcp_f32 v154, v154
    v_mfma_f32_16x16x32_bf16 v[132:135], v[124:127], v[188:191], v[132:135]
    v_rcp_f32 v155, v155
    v_mfma_f32_16x16x32_bf16 v[136:139], v[128:131], v[188:191], v[136:139]
    s_waitcnt lgkmcnt(4)
    v_cvt_pk_bf16_f32 v158, v152, v153
    v_cvt_pk_bf16_f32 v159, v154, v155
    v_mfma_f32_16x16x32_bf16 v[140:143], v[68:71], v[160:163], v[140:143]
    s_waitcnt lgkmcnt(3)
    ds_read_b128 v[176:179], v33 offset:28672
    v_exp_f32 v148, v132
    v_mfma_f32_16x16x32_bf16 v[52:55], v[48:51], v[156:159], v[52:55]
    v_exp_f32 v149, v133
    v_mfma_f32_16x16x32_bf16 v[144:147], v[72:75], v[160:163], v[144:147]
    s_waitcnt lgkmcnt(3)
    ds_read_i16 v25, v20 offset:18240
    v_exp_f32 v150, v134
    v_mfma_f32_16x16x32_bf16 v[140:143], v[76:79], v[164:167], v[140:143]
    ds_read_b128 v[180:183], v34 offset:28672
    v_exp_f32 v151, v135
    v_mfma_f32_16x16x32_bf16 v[144:147], v[80:83], v[164:167], v[144:147]
    s_waitcnt lgkmcnt(4)
    v_exp_f32 v152, v136
    v_mfma_f32_16x16x32_bf16 v[140:143], v[84:87], v[168:171], v[140:143]
    ds_read_b128 v[184:187], v35 offset:28672
    v_exp_f32 v153, v137
    v_mfma_f32_4x4x4_16b_bf16 v[148:151], v[64:65], v[64:65], v[148:151]
    v_exp_f32 v154, v138
    v_mfma_f32_16x16x32_bf16 v[144:147], v[88:91], v[168:171], v[144:147]
    s_waitcnt lgkmcnt(2)
    ds_write_b32 v23, v52 offset:14336
    v_add_co_u32 v22, vcc, v25, v21
    v_exp_f32 v155, v139
    v_mfma_f32_16x16x32_bf16 v[140:143], v[92:95], v[172:175], v[140:143]
    ds_read_b128 v[188:191], v36 offset:28672
    v_rcp_f32 v148, v148
    v_mfma_f32_16x16x32_bf16 v[144:147], v[96:99], v[172:175], v[144:147]
    v_rcp_f32 v149, v149
    s_cbranch_vccnz L_slow9
L_back9:
    v_mfma_f32_16x16x32_bf16 v[140:143], v[100:103], v[176:179], v[140:143]
    ds_read_b128 v[132:135], v22 offset:0
    v_rcp_f32 v150, v150
    v_mfma_f32_4x4x4_16b_bf16 v[152:155], v[64:65], v[64:65], v[152:155]
    v_rcp_f32 v151, v151
    v_mfma_f32_16x16x32_bf16 v[144:147], v[104:107], v[176:179], v[144:147]
    s_waitcnt lgkmcnt(4)
    ds_read_b128 v[160:163], v29 offset:57344
    v_cvt_pk_bf16_f32 v156, v148, v149
    v_mfma_f32_16x16x32_bf16 v[140:143], v[108:111], v[180:183], v[140:143]
    ds_read_b128 v[136:139], v22 offset:64
    v_cvt_pk_bf16_f32 v157, v150, v151
    v_mfma_f32_16x16x32_bf16 v[144:147], v[112:115], v[180:183], v[144:147]
    s_waitcnt lgkmcnt(5)
    ds_read_b128 v[164:167], v30 offset:57344
    v_rcp_f32 v152, v152
    v_mfma_f32_16x16x32_bf16 v[140:143], v[116:119], v[184:187], v[140:143]
    ds_read_b128 v[168:171], v31 offset:57344
    v_rcp_f32 v153, v153
    v_mfma_f32_16x16x32_bf16 v[144:147], v[120:123], v[184:187], v[144:147]
    s_waitcnt lgkmcnt(5)
    ds_read_b128 v[172:175], v32 offset:57344
    v_rcp_f32 v154, v154
    v_mfma_f32_16x16x32_bf16 v[140:143], v[124:127], v[188:191], v[140:143]
    v_rcp_f32 v155, v155
    v_mfma_f32_16x16x32_bf16 v[144:147], v[128:131], v[188:191], v[144:147]
    s_waitcnt lgkmcnt(4)
    v_cvt_pk_bf16_f32 v158, v152, v153
    v_cvt_pk_bf16_f32 v159, v154, v155
    v_mfma_f32_16x16x32_bf16 v[132:135], v[68:71], v[160:163], v[132:135]
    s_waitcnt lgkmcnt(3)
    ds_read_b128 v[176:179], v33 offset:32768
    v_exp_f32 v148, v140
    v_mfma_f32_16x16x32_bf16 v[52:55], v[44:47], v[156:159], v[60:63]
    v_exp_f32 v149, v141
    v_mfma_f32_16x16x32_bf16 v[136:139], v[72:75], v[160:163], v[136:139]
    s_waitcnt lgkmcnt(3)
    ds_read_i16 v25, v20 offset:18272
    v_exp_f32 v150, v142
    v_mfma_f32_16x16x32_bf16 v[132:135], v[76:79], v[164:167], v[132:135]
    ds_read_b128 v[180:183], v34 offset:32768
    v_exp_f32 v151, v143
    v_mfma_f32_16x16x32_bf16 v[136:139], v[80:83], v[164:167], v[136:139]
    s_waitcnt lgkmcnt(4)
    v_exp_f32 v152, v144
    v_mfma_f32_16x16x32_bf16 v[132:135], v[84:87], v[168:171], v[132:135]
    ds_read_b128 v[184:187], v35 offset:32768
    v_exp_f32 v153, v145
    v_mfma_f32_4x4x4_16b_bf16 v[148:151], v[64:65], v[64:65], v[148:151]
    v_exp_f32 v154, v146
    v_mfma_f32_16x16x32_bf16 v[136:139], v[88:91], v[168:171], v[136:139]
    s_waitcnt lgkmcnt(2)
    v_add_co_u32 v22, vcc, v25, v21
    v_exp_f32 v155, v147
    v_mfma_f32_16x16x32_bf16 v[132:135], v[92:95], v[172:175], v[132:135]
    ds_read_b128 v[188:191], v36 offset:32768
    v_rcp_f32 v148, v148
    v_mfma_f32_16x16x32_bf16 v[136:139], v[96:99], v[172:175], v[136:139]
    v_rcp_f32 v149, v149
    s_cbranch_vccnz L_slow10
L_back10:
    v_mfma_f32_16x16x32_bf16 v[132:135], v[100:103], v[176:179], v[132:135]
    ds_read_b128 v[140:143], v22 offset:0
    v_rcp_f32 v150, v150
    v_mfma_f32_4x4x4_16b_bf16 v[152:155], v[64:65], v[64:65], v[152:155]
    v_rcp_f32 v151, v151
    v_mfma_f32_16x16x32_bf16 v[136:139], v[104:107], v[176:179], v[136:139]
    s_waitcnt lgkmcnt(3)
    ds_read_b128 v[160:163], v29 offset:61440
    v_cvt_pk_bf16_f32 v156, v148, v149
    v_mfma_f32_16x16x32_bf16 v[132:135], v[108:111], v[180:183], v[132:135]
    ds_read_b128 v[144:147], v22 offset:64
    v_cvt_pk_bf16_f32 v157, v150, v151
    v_mfma_f32_16x16x32_bf16 v[136:139], v[112:115], v[180:183], v[136:139]
    s_waitcnt lgkmcnt(4)
    ds_read_b128 v[164:167], v30 offset:61440
    v_rcp_f32 v152, v152
    v_mfma_f32_16x16x32_bf16 v[132:135], v[116:119], v[184:187], v[132:135]
    ds_read_b128 v[168:171], v31 offset:61440
    v_rcp_f32 v153, v153
    v_mfma_f32_16x16x32_bf16 v[136:139], v[120:123], v[184:187], v[136:139]
    s_waitcnt lgkmcnt(5)
    ds_read_b128 v[172:175], v32 offset:61440
    v_rcp_f32 v154, v154
    v_mfma_f32_16x16x32_bf16 v[132:135], v[124:127], v[188:191], v[132:135]
    v_rcp_f32 v155, v155
    v_mfma_f32_16x16x32_bf16 v[136:139], v[128:131], v[188:191], v[136:139]
    s_waitcnt lgkmcnt(4)
    v_cvt_pk_bf16_f32 v158, v152, v153
    v_cvt_pk_bf16_f32 v159, v154, v155
    v_mfma_f32_16x16x32_bf16 v[140:143], v[68:71], v[160:163], v[140:143]
    s_waitcnt lgkmcnt(3)
    ds_read_b128 v[176:179], v33 offset:36864
    v_exp_f32 v148, v132
    v_mfma_f32_16x16x32_bf16 v[52:55], v[48:51], v[156:159], v[52:55]
    v_exp_f32 v149, v133
    v_mfma_f32_16x16x32_bf16 v[144:147], v[72:75], v[160:163], v[144:147]
    s_waitcnt lgkmcnt(3)
    ds_read_i16 v25, v20 offset:18304
    v_exp_f32 v150, v134
    v_mfma_f32_16x16x32_bf16 v[140:143], v[76:79], v[164:167], v[140:143]
    ds_read_b128 v[180:183], v34 offset:36864
    v_exp_f32 v151, v135
    v_mfma_f32_16x16x32_bf16 v[144:147], v[80:83], v[164:167], v[144:147]
    s_waitcnt lgkmcnt(4)
    v_exp_f32 v152, v136
    v_mfma_f32_16x16x32_bf16 v[140:143], v[84:87], v[168:171], v[140:143]
    ds_read_b128 v[184:187], v35 offset:36864
    v_exp_f32 v153, v137
    v_mfma_f32_4x4x4_16b_bf16 v[148:151], v[64:65], v[64:65], v[148:151]
    v_exp_f32 v154, v138
    v_mfma_f32_16x16x32_bf16 v[144:147], v[88:91], v[168:171], v[144:147]
    s_waitcnt lgkmcnt(2)
    ds_write_b32 v23, v52 offset:14848
    v_add_co_u32 v22, vcc, v25, v21
    v_exp_f32 v155, v139
    v_mfma_f32_16x16x32_bf16 v[140:143], v[92:95], v[172:175], v[140:143]
    ds_read_b128 v[188:191], v36 offset:36864
    v_rcp_f32 v148, v148
    v_mfma_f32_16x16x32_bf16 v[144:147], v[96:99], v[172:175], v[144:147]
    v_rcp_f32 v149, v149
    s_cbranch_vccnz L_slow11
    s_branch L_back11
.p2align 12
L_touch12:
    s_setpc_b64 s[60:61]
L_back11:
    v_mfma_f32_16x16x32_bf16 v[140:143], v[100:103], v[176:179], v[140:143]
    ds_read_b128 v[132:135], v22 offset:0
    v_rcp_f32 v150, v150
    v_mfma_f32_4x4x4_16b_bf16 v[152:155], v[64:65], v[64:65], v[152:155]
    v_rcp_f32 v151, v151
    v_mfma_f32_16x16x32_bf16 v[144:147], v[104:107], v[176:179], v[144:147]
    s_waitcnt lgkmcnt(4)
    ds_read_b128 v[160:163], v33 offset:0
    v_cvt_pk_bf16_f32 v156, v148, v149
    v_mfma_f32_16x16x32_bf16 v[140:143], v[108:111], v[180:183], v[140:143]
    ds_read_b128 v[136:139], v22 offset:64
    v_cvt_pk_bf16_f32 v157, v150, v151
    v_mfma_f32_16x16x32_bf16 v[144:147], v[112:115], v[180:183], v[144:147]
    s_waitcnt lgkmcnt(5)
    ds_read_b128 v[164:167], v34 offset:0
    v_rcp_f32 v152, v152
    v_mfma_f32_16x16x32_bf16 v[140:143], v[116:119], v[184:187], v[140:143]
    ds_read_b128 v[168:171], v35 offset:0
    v_rcp_f32 v153, v153
    v_mfma_f32_16x16x32_bf16 v[144:147], v[120:123], v[184:187], v[144:147]
    s_waitcnt lgkmcnt(5)
    ds_read_b128 v[172:175], v36 offset:0
    v_rcp_f32 v154, v154
    v_mfma_f32_16x16x32_bf16 v[140:143], v[124:127], v[188:191], v[140:143]
    v_rcp_f32 v155, v155
    v_mfma_f32_16x16x32_bf16 v[144:147], v[128:131], v[188:191], v[144:147]
    s_waitcnt lgkmcnt(4)
    v_cvt_pk_bf16_f32 v158, v152, v153
    v_cvt_pk_bf16_f32 v159, v154, v155
    s_cmp_le_u32 s30, 14
    s_cbranch_scc1 L_nobar
    s_barrier
L_nobar:
    v_mfma_f32_16x16x32_bf16 v[132:135], v[68:71], v[160:163], v[132:135]
    s_waitcnt lgkmcnt(3)
    ds_read_b128 v[176:179], v33 offset:40960
    v_exp_f32 v148, v140
    v_mfma_f32_16x16x32_bf16 v[52:55], v[44:47], v[156:159], v[60:63]
    v_exp_f32 v149, v141
    v_mfma_f32_16x16x32_bf16 v[136:139], v[72:75], v[160:163], v[136:139]
    s_waitcnt lgkmcnt(3)
    ds_read_i16 v25, v20 offset:18336
    v_exp_f32 v150, v142
    v_mfma_f32_16x16x32_bf16 v[132:135], v[76:79], v[164:167], v[132:135]
    ds_read_b128 v[180:183], v34 offset:40960
    v_exp_f32 v151, v143
    v_mfma_f32_16x16x32_bf16 v[136:139], v[80:83], v[164:167], v[136:139]
    s_waitcnt lgkmcnt(4)
    v_exp_f32 v152, v144
    v_mfma_f32_16x16x32_bf16 v[132:135], v[84:87], v[168:171], v[132:135]
    ds_read_b128 v[184:187], v35 offset:40960
    v_exp_f32 v153, v145
    v_mfma_f32_4x4x4_16b_bf16 v[148:151], v[64:65], v[64:65], v[148:151]
    v_exp_f32 v154, v146
    v_mfma_f32_16x16x32_bf16 v[136:139], v[88:91], v[168:171], v[136:139]
    s_waitcnt lgkmcnt(2)
    v_add_co_u32 v22, vcc, v25, v21
    v_exp_f32 v155, v147
    v_mfma_f32_16x16x32_bf16 v[132:135], v[92:95], v[172:175], v[132:135]
    ds_read_b128 v[188:191], v36 offset:40960
    v_rcp_f32 v148, v148
    v_mfma_f32_16x16x32_bf16 v[136:139], v[96:99], v[172:175], v[136:139]
    v_rcp_f32 v149, v149
    s_cbranch_vccnz L_slow12
L_back12:
    v_mfma_f32_16x16x32_bf16 v[132:135], v[100:103], v[176:179], v[132:135]
    ds_read_b128 v[140:143], v22 offset:0
    v_rcp_f32 v150, v150
    v_mfma_f32_4x4x4_16b_bf16 v[152:155], v[64:65], v[64:65], v[152:155]
    v_rcp_f32 v151, v151
    v_mfma_f32_16x16x32_bf16 v[136:139], v[104:107], v[176:179], v[136:139]
    s_waitcnt lgkmcnt(3)
    ds_read_b128 v[160:163], v33 offset:4096
    v_cvt_pk_bf16_f32 v156, v148, v149
    v_mfma_f32_16x16x32_bf16 v[132:135], v[108:111], v[180:183], v[132:135]
    ds_read_b128 v[144:147], v22 offset:64
    v_cvt_pk_bf16_f32 v157, v150, v151
    v_mfma_f32_16x16x32_bf16 v[136:139], v[112:115], v[180:183], v[136:139]
    s_waitcnt lgkmcnt(4)
    ds_read_b128 v[164:167], v34 offset:4096
    v_rcp_f32 v152, v152
    v_mfma_f32_16x16x32_bf16 v[132:135], v[116:119], v[184:187], v[132:135]
    ds_read_b128 v[168:171], v35 offset:4096
    v_rcp_f32 v153, v153
    v_mfma_f32_16x16x32_bf16 v[136:139], v[120:123], v[184:187], v[136:139]
    s_waitcnt lgkmcnt(5)
    ds_read_b128 v[172:175], v36 offset:4096
    v_rcp_f32 v154, v154
    v_mfma_f32_16x16x32_bf16 v[132:135], v[124:127], v[188:191], v[132:135]
    v_rcp_f32 v155, v155
    v_mfma_f32_16x16x32_bf16 v[136:139], v[128:131], v[188:191], v[136:139]
    s_waitcnt lgkmcnt(4)
    v_cvt_pk_bf16_f32 v158, v152, v153
    v_cvt_pk_bf16_f32 v159, v154, v155
    v_mfma_f32_16x16x32_bf16 v[140:143], v[68:71], v[160:163], v[140:143]
    s_waitcnt lgkmcnt(3)
    ds_read_b128 v[176:179], v33 offset:45056
    v_exp_f32 v148, v132
    v_mfma_f32_16x16x32_bf16 v[52:55], v[48:51], v[156:159], v[52:55]
    v_exp_f32 v149, v133
    v_mfma_f32_16x16x32_bf16 v[144:147], v[72:75], v[160:163], v[144:147]
    s_waitcnt lgkmcnt(3)
    ds_read_i16 v25, v20 offset:18368
    v_exp_f32 v150, v134
    v_mfma_f32_16x16x32_bf16 v[140:143], v[76:79], v[164:167], v[140:143]
    ds_read_b128 v[180:183], v34 offset:45056
    v_exp_f32 v151, v135
    v_mfma_f32_16x16x32_bf16 v[144:147], v[80:83], v[164:167], v[144:147]
    s_waitcnt lgkmcnt(4)
    v_exp_f32 v152, v136
    v_mfma_f32_16x16x32_bf16 v[140:143], v[84:87], v[168:171], v[140:143]
    ds_read_b128 v[184:187], v35 offset:45056
    v_exp_f32 v153, v137
    v_mfma_f32_4x4x4_16b_bf16 v[148:151], v[64:65], v[64:65], v[148:151]
    v_exp_f32 v154, v138
    v_mfma_f32_16x16x32_bf16 v[144:147], v[88:91], v[168:171], v[144:147]
    s_waitcnt lgkmcnt(2)
    ds_write_b32 v23, v52 offset:15360
    v_add_co_u32 v22, vcc, v25, v21
    v_exp_f32 v155, v139
    v_mfma_f32_16x16x32_bf16 v[140:143], v[92:95], v[172:175], v[140:143]
    ds_read_b128 v[188:191], v36 offset:45056
    v_rcp_f32 v148, v148
    v_mfma_f32_16x16x32_bf16 v[144:147], v[96:99], v[172:175], v[144:147]
    v_rcp_f32 v149, v149
    s_cbranch_vccnz L_slow13
L_back13:
    v_mfma_f32_16x16x32_bf16 v[140:143], v[100:103], v[176:179], v[140:143]
    ds_read_b128 v[132:135], v22 offset:0
    v_rcp_f32 v150, v150
    v_mfma_f32_4x4x4_16b_bf16 v[152:155], v[64:65], v[64:65], v[152:155]
    v_rcp_f32 v151, v151
    v_mfma_f32_16x16x32_bf16 v[144:147], v[104:107], v[176:179], v[144:147]
    s_waitcnt lgkmcnt(4)
    ds_read_b128 v[160:163], v33 offset:8192
    v_cvt_pk_bf16_f32 v156, v148, v149
    v_mfma_f32_16x16x32_bf16 v[140:143], v[108:111], v[180:183], v[140:143]
    ds_read_b128 v[136:139], v22 offset:64
    v_cvt_pk_bf16_f32 v157, v150, v151
    v_mfma_f32_16x16x32_bf16 v[144:147], v[112:115], v[180:183], v[144:147]
    s_waitcnt lgkmcnt(5)
    ds_read_b128 v[164:167], v34 offset:8192
    v_rcp_f32 v152, v152
    v_mfma_f32_16x16x32_bf16 v[140:143], v[116:119], v[184:187], v[140:143]
    ds_read_b128 v[168:171], v35 offset:8192
    v_rcp_f32 v153, v153
    v_mfma_f32_16x16x32_bf16 v[144:147], v[120:123], v[184:187], v[144:147]
    s_waitcnt lgkmcnt(5)
    ds_read_b128 v[172:175], v36 offset:8192
    v_rcp_f32 v154, v154
    v_mfma_f32_16x16x32_bf16 v[140:143], v[124:127], v[188:191], v[140:143]
    v_rcp_f32 v155, v155
    v_mfma_f32_16x16x32_bf16 v[144:147], v[128:131], v[188:191], v[144:147]
    s_waitcnt lgkmcnt(4)
    v_cvt_pk_bf16_f32 v158, v152, v153
    v_cvt_pk_bf16_f32 v159, v154, v155
    v_mfma_f32_16x16x32_bf16 v[132:135], v[68:71], v[160:163], v[132:135]
    s_waitcnt lgkmcnt(3)
    ds_read_b128 v[176:179], v29 offset:0
    v_exp_f32 v148, v140
    v_mfma_f32_16x16x32_bf16 v[52:55], v[44:47], v[156:159], v[60:63]
    v_exp_f32 v149, v141
    v_mfma_f32_16x16x32_bf16 v[136:139], v[72:75], v[160:163], v[136:139]
    s_waitcnt lgkmcnt(3)
    ds_read_i16 v25, v20 offset:18400
    v_exp_f32 v150, v142
    v_mfma_f32_16x16x32_bf16 v[132:135], v[76:79], v[164:167], v[132:135]
    ds_read_b128 v[180:183], v30 offset:0
    v_exp_f32 v151, v143
    v_mfma_f32_16x16x32_bf16 v[136:139], v[80:83], v[164:167], v[136:139]
    s_waitcnt lgkmcnt(4)
    v_exp_f32 v152, v144
    v_mfma_f32_16x16x32_bf16 v[132:135], v[84:87], v[168:171], v[132:135]
    ds_read_b128 v[184:187], v31 offset:0
    v_exp_f32 v153, v145
    v_mfma_f32_4x4x4_16b_bf16 v[148:151], v[64:65], v[64:65], v[148:151]
    v_exp_f32 v154, v146
    v_mfma_f32_16x16x32_bf16 v[136:139], v[88:91], v[168:171], v[136:139]
    s_waitcnt lgkmcnt(2)
    v_add_co_u32 v22, vcc, v25, v21
    v_exp_f32 v155, v147
    v_mfma_f32_16x16x32_bf16 v[132:135], v[92:95], v[172:175], v[132:135]
    ds_read_b128 v[188:191], v32 offset:0
    v_rcp_f32 v148, v148
    v_mfma_f32_16x16x32_bf16 v[136:139], v[96:99], v[172:175], v[136:139]
    v_rcp_f32 v149, v149
    s_cbranch_vccnz L_slow14
L_back14:
    v_mfma_f32_16x16x32_bf16 v[132:135], v[100:103], v[176:179], v[132:135]
    ds_read_b128 v[140:143], v22 offset:0
    v_rcp_f32 v150, v150
    v_mfma_f32_4x4x4_16b_bf16 v[152:155], v[64:65], v[64:65], v[152:155]
    v_rcp_f32 v151, v151
    v_mfma_f32_16x16x32_bf16 v[136:139], v[104:107], v[176:179], v[136:139]
    s_waitcnt lgkmcnt(3)
    ds_read_b128 v[160:163], v33 offset:12288
    v_cvt_pk_bf16_f32 v156, v148, v149
    v_mfma_f32_16x16x32_bf16 v[132:135], v[108:111], v[180:183], v[132:135]
    ds_read_b128 v[144:147], v22 offset:64
    v_cvt_pk_bf16_f32 v157, v150, v151
    v_mfma_f32_16x16x32_bf16 v[136:139], v[112:115], v[180:183], v[136:139]
    s_waitcnt lgkmcnt(4)
    ds_read_b128 v[164:167], v34 offset:12288
    v_rcp_f32 v152, v152
    v_mfma_f32_16x16x32_bf16 v[132:135], v[116:119], v[184:187], v[132:135]
    ds_read_b128 v[168:171], v35 offset:12288
    v_rcp_f32 v153, v153
    v_mfma_f32_16x16x32_bf16 v[136:139], v[120:123], v[184:187], v[136:139]
    s_waitcnt lgkmcnt(5)
    ds_read_b128 v[172:175], v36 offset:12288
    v_rcp_f32 v154, v154
    v_mfma_f32_16x16x32_bf16 v[132:135], v[124:127], v[188:191], v[132:135]
    v_rcp_f32 v155, v155
    v_mfma_f32_16x16x32_bf16 v[136:139], v[128:131], v[188:191], v[136:139]
    s_waitcnt lgkmcnt(4)
    v_cvt_pk_bf16_f32 v158, v152, v153
    v_cvt_pk_bf16_f32 v159, v154, v155
    v_mfma_f32_16x16x32_bf16 v[140:143], v[68:71], v[160:163], v[140:143]
    s_waitcnt lgkmcnt(3)
    ds_read_b128 v[176:179], v29 offset:4096
    v_exp_f32 v148, v132
    v_mfma_f32_16x16x32_bf16 v[52:55], v[48:51], v[156:159], v[52:55]
    v_exp_f32 v149, v133
    v_mfma_f32_16x16x32_bf16 v[144:147], v[72:75], v[160:163], v[144:147]
    s_waitcnt lgkmcnt(3)
    ds_read_i16 v25, v20 offset:18432
    v_exp_f32 v150, v134
    v_mfma_f32_16x16x32_bf16 v[140:143], v[76:79], v[164:167], v[140:143]
    ds_read_b128 v[180:183], v30 offset:4096
    v_exp_f32 v151, v135
    v_mfma_f32_16x16x32_bf16 v[144:147], v[80:83], v[164:167], v[144:147]
    s_waitcnt lgkmcnt(4)
    v_exp_f32 v152, v136
    v_mfma_f32_16x16x32_bf16 v[140:143], v[84:87], v[168:171], v[140:143]
    ds_read_b128 v[184:187], v31 offset:4096
    v_exp_f32 v153, v137
    v_mfma_f32_4x4x4_16b_bf16 v[148:151], v[64:65], v[64:65], v[148:151]
    v_exp_f32 v154, v138
    v_mfma_f32_16x16x32_bf16 v[144:147], v[88:91], v[168:171], v[144:147]
    s_waitcnt lgkmcnt(2)
    ds_write_b32 v23, v52 offset:15872
    v_add_co_u32 v22, vcc, v25, v21
    v_exp_f32 v155, v139
    v_mfma_f32_16x16x32_bf16 v[140:143], v[92:95], v[172:175], v[140:143]
    ds_read_b128 v[188:191], v32 offset:4096
    v_rcp_f32 v148, v148
    v_mfma_f32_16x16x32_bf16 v[144:147], v[96:99], v[172:175], v[144:147]
    v_rcp_f32 v149, v149
    s_cbranch_vccnz L_slow15
L_back15:
    v_mfma_f32_16x16x32_bf16 v[140:143], v[100:103], v[176:179], v[140:143]
    ds_read_b128 v[132:135], v22 offset:0
    v_rcp_f32 v150, v150
    v_mfma_f32_4x4x4_16b_bf16 v[152:155], v[64:65], v[64:65], v[152:155]
    v_rcp_f32 v151, v151
    v_mfma_f32_16x16x32_bf16 v[144:147], v[104:107], v[176:179], v[144:147]
    s_waitcnt lgkmcnt(4)
    ds_read_b128 v[160:163], v33 offset:16384
    v_cvt_pk_bf16_f32 v156, v148, v149
    v_mfma_f32_16x16x32_bf16 v[140:143], v[108:111], v[180:183], v[140:143]
    ds_read_b128 v[136:139], v22 offset:64
    v_cvt_pk_bf16_f32 v157, v150, v151
    v_mfma_f32_16x16x32_bf16 v[144:147], v[112:115], v[180:183], v[144:147]
    s_waitcnt lgkmcnt(5)
    ds_read_b128 v[164:167], v34 offset:16384
    v_rcp_f32 v152, v152
    v_mfma_f32_16x16x32_bf16 v[140:143], v[116:119], v[184:187], v[140:143]
    ds_read_b128 v[168:171], v35 offset:16384
    v_rcp_f32 v153, v153
    v_mfma_f32_16x16x32_bf16 v[144:147], v[120:123], v[184:187], v[144:147]
    s_waitcnt lgkmcnt(5)
    ds_read_b128 v[172:175], v36 offset:16384
    v_rcp_f32 v154, v154
    v_mfma_f32_16x16x32_bf16 v[140:143], v[124:127], v[188:191], v[140:143]
    v_rcp_f32 v155, v155
    v_mfma_f32_16x16x32_bf16 v[144:147], v[128:131], v[188:191], v[144:147]
    s_waitcnt lgkmcnt(4)
    v_cvt_pk_bf16_f32 v158, v152, v153
    v_cvt_pk_bf16_f32 v159, v154, v155
    v_mfma_f32_16x16x32_bf16 v[132:135], v[68:71], v[160:163], v[132:135]
    s_waitcnt lgkmcnt(3)
    ds_read_b128 v[176:179], v29 offset:8192
    v_exp_f32 v148, v140
    v_mfma_f32_16x16x32_bf16 v[52:55], v[44:47], v[156:159], v[60:63]
    v_exp_f32 v149, v141
    v_mfma_f32_16x16x32_bf16 v[136:139], v[72:75], v[160:163], v[136:139]
    s_waitcnt lgkmcnt(3)
    ds_read_i16 v25, v20 offset:18464
    v_exp_f32 v150, v142
    v_mfma_f32_16x16x32_bf16 v[132:135], v[76:79], v[164:167], v[132:135]
    ds_read_b128 v[180:183], v30 offset:8192
    v_exp_f32 v151, v143
    v_mfma_f32_16x16x32_bf16 v[136:139], v[80:83], v[164:167], v[136:139]
    s_waitcnt lgkmcnt(4)
    v_exp_f32 v152, v144
    v_mfma_f32_16x16x32_bf16 v[132:135], v[84:87], v[168:171], v[132:135]
    ds_read_b128 v[184:187], v31 offset:8192
    v_exp_f32 v153, v145
    v_mfma_f32_4x4x4_16b_bf16 v[148:151], v[64:65], v[64:65], v[148:151]
    v_exp_f32 v154, v146
    v_mfma_f32_16x16x32_bf16 v[136:139], v[88:91], v[168:171], v[136:139]
    s_waitcnt lgkmcnt(2)
    v_add_co_u32 v22, vcc, v25, v21
    v_exp_f32 v155, v147
    v_mfma_f32_16x16x32_bf16 v[132:135], v[92:95], v[172:175], v[132:135]
    ds_read_b128 v[188:191], v32 offset:8192
    v_rcp_f32 v148, v148
    v_mfma_f32_16x16x32_bf16 v[136:139], v[96:99], v[172:175], v[136:139]
    v_rcp_f32 v149, v149
    s_cbranch_vccnz L_slow16
L_back16:
    v_mfma_f32_16x16x32_bf16 v[132:135], v[100:103], v[176:179], v[132:135]
    ds_read_b128 v[140:143], v22 offset:0
    v_rcp_f32 v150, v150
    v_mfma_f32_4x4x4_16b_bf16 v[152:155], v[64:65], v[64:65], v[152:155]
    v_rcp_f32 v151, v151
    v_mfma_f32_16x16x32_bf16 v[136:139], v[104:107], v[176:179], v[136:139]
    s_waitcnt lgkmcnt(3)
    ds_read_b128 v[160:163], v33 offset:20480
    v_cvt_pk_bf16_f32 v156, v148, v149
    v_mfma_f32_16x16x32_bf16 v[132:135], v[108:111], v[180:183], v[132:135]
    ds_read_b128 v[144:147], v22 offset:64
    v_cvt_pk_bf16_f32 v157, v150, v151
    v_mfma_f32_16x16x32_bf16 v[136:139], v[112:115], v[180:183], v[136:139]
    s_waitcnt lgkmcnt(4)
    ds_read_b128 v[164:167], v34 offset:20480
    v_rcp_f32 v152, v152
    v_mfma_f32_16x16x32_bf16 v[132:135], v[116:119], v[184:187], v[132:135]
    ds_read_b128 v[168:171], v35 offset:20480
    v_rcp_f32 v153, v153
    v_mfma_f32_16x16x32_bf16 v[136:139], v[120:123], v[184:187], v[136:139]
    s_waitcnt lgkmcnt(5)
    ds_read_b128 v[172:175], v36 offset:20480
    v_rcp_f32 v154, v154
    v_mfma_f32_16x16x32_bf16 v[132:135], v[124:127], v[188:191], v[132:135]
    v_rcp_f32 v155, v155
    v_mfma_f32_16x16x32_bf16 v[136:139], v[128:131], v[188:191], v[136:139]
    s_waitcnt lgkmcnt(4)
    v_cvt_pk_bf16_f32 v158, v152, v153
    v_cvt_pk_bf16_f32 v159, v154, v155
    v_mfma_f32_16x16x32_bf16 v[140:143], v[68:71], v[160:163], v[140:143]
    s_waitcnt lgkmcnt(3)
    ds_read_b128 v[176:179], v29 offset:12288
    v_exp_f32 v148, v132
    v_mfma_f32_16x16x32_bf16 v[52:55], v[48:51], v[156:159], v[52:55]
    v_exp_f32 v149, v133
    v_mfma_f32_16x16x32_bf16 v[144:147], v[72:75], v[160:163], v[144:147]
    s_waitcnt lgkmcnt(3)
    ds_read_i16 v25, v20 offset:18496
    v_exp_f32 v150, v134
    v_mfma_f32_16x16x32_bf16 v[140:143], v[76:79], v[164:167], v[140:143]
    ds_read_b128 v[180:183], v30 offset:12288
    v_exp_f32 v151, v135
    v_mfma_f32_16x16x32_bf16 v[144:147], v[80:83], v[164:167], v[144:147]
    s_waitcnt lgkmcnt(4)
    v_exp_f32 v152, v136
    v_mfma_f32_16x16x32_bf16 v[140:143], v[84:87], v[168:171], v[140:143]
    ds_read_b128 v[184:187], v31 offset:12288
    v_exp_f32 v153, v137
    v_mfma_f32_4x4x4_16b_bf16 v[148:151], v[64:65], v[64:65], v[148:151]
    v_exp_f32 v154, v138
    v_mfma_f32_16x16x32_bf16 v[144:147], v[88:91], v[168:171], v[144:147]
    s_waitcnt lgkmcnt(2)
    ds_write_b32 v23, v52 offset:16384
    v_add_co_u32 v22, vcc, v25, v21
    v_exp_f32 v155, v139
    v_mfma_f32_16x16x32_bf16 v[140:143], v[92:95], v[172:175], v[140:143]
    ds_read_b128 v[188:191], v32 offset:12288
    v_rcp_f32 v148, v148
    v_mfma_f32_16x16x32_bf16 v[144:147], v[96:99], v[172:175], v[144:147]
    v_rcp_f32 v149, v149
    s_cbranch_vccnz L_slow17
L_back17:
    v_mfma_f32_16x16x32_bf16 v[140:143], v[100:103], v[176:179], v[140:143]
    ds_read_b128 v[132:135], v22 offset:0
    v_rcp_f32 v150, v150
    v_mfma_f32_4x4x4_16b_bf16 v[152:155], v[64:65], v[64:65], v[152:155]
    v_rcp_f32 v151, v151
    v_mfma_f32_16x16x32_bf16 v[144:147], v[104:107], v[176:179], v[144:147]
    s_waitcnt lgkmcnt(4)
    ds_read_b128 v[160:163], v33 offset:24576
    v_cvt_pk_bf16_f32 v156, v148, v149
    v_mfma_f32_16x16x32_bf16 v[140:143], v[108:111], v[180:183], v[140:143]
    ds_read_b128 v[136:139], v22 offset:64
    v_cvt_pk_bf16_f32 v157, v150, v151
    v_mfma_f32_16x16x32_bf16 v[144:147], v[112:115], v[180:183], v[144:147]
    s_waitcnt lgkmcnt(5)
    ds_read_b128 v[164:167], v34 offset:24576
    v_rcp_f32 v152, v152
    v_mfma_f32_16x16x32_bf16 v[140:143], v[116:119], v[184:187], v[140:143]
    ds_read_b128 v[168:171], v35 offset:24576
    v_rcp_f32 v153, v153
    v_mfma_f32_16x16x32_bf16 v[144:147], v[120:123], v[184:187], v[144:147]
    s_waitcnt lgkmcnt(5)
    ds_read_b128 v[172:175], v36 offset:24576
    v_rcp_f32 v154, v154
    v_mfma_f32_16x16x32_bf16 v[140:143], v[124:127], v[188:191], v[140:143]
    v_rcp_f32 v155, v155
    v_mfma_f32_16x16x32_bf16 v[144:147], v[128:131], v[188:191], v[144:147]
    s_waitcnt lgkmcnt(4)
    v_cvt_pk_bf16_f32 v158, v152, v153
    v_cvt_pk_bf16_f32 v159, v154, v155
    v_mfma_f32_16x16x32_bf16 v[132:135], v[68:71], v[160:163], v[132:135]
    s_waitcnt lgkmcnt(3)
    ds_read_b128 v[176:179], v33 offset:32768
    v_exp_f32 v148, v140
    v_mfma_f32_16x16x32_bf16 v[52:55], v[44:47], v[156:159], v[60:63]
    v_exp_f32 v149, v141
    v_mfma_f32_16x16x32_bf16 v[136:139], v[72:75], v[160:163], v[136:139]
    s_waitcnt lgkmcnt(3)
    ds_read_i16 v25, v20 offset:18528
    v_exp_f32 v150, v142
    v_mfma_f32_16x16x32_bf16 v[132:135], v[76:79], v[164:167], v[132:135]
    ds_read_b128 v[180:183], v34 offset:32768
    v_exp_f32 v151, v143
    v_mfma_f32_16x16x32_bf16 v[136:139], v[80:83], v[164:167], v[136:139]
    s_waitcnt lgkmcnt(4)
    v_exp_f32 v152, v144
    v_mfma_f32_16x16x32_bf16 v[132:135], v[84:87], v[168:171], v[132:135]
    ds_read_b128 v[184:187], v35 offset:32768
    v_exp_f32 v153, v145
    v_mfma_f32_4x4x4_16b_bf16 v[148:151], v[64:65], v[64:65], v[148:151]
    v_exp_f32 v154, v146
    v_mfma_f32_16x16x32_bf16 v[136:139], v[88:91], v[168:171], v[136:139]
    s_waitcnt lgkmcnt(2)
    v_add_co_u32 v22, vcc, v25, v21
    v_exp_f32 v155, v147
    v_mfma_f32_16x16x32_bf16 v[132:135], v[92:95], v[172:175], v[132:135]
    ds_read_b128 v[188:191], v36 offset:32768
    v_rcp_f32 v148, v148
    v_mfma_f32_16x16x32_bf16 v[136:139], v[96:99], v[172:175], v[136:139]
    v_rcp_f32 v149, v149
    s_cbranch_vccnz L_slow18
L_back18:
    v_mfma_f32_16x16x32_bf16 v[132:135], v[100:103], v[176:179], v[132:135]
    ds_read_b128 v[140:143], v22 offset:0
    v_rcp_f32 v150, v150
    v_mfma_f32_4x4x4_16b_bf16 v[152:155], v[64:65], v[64:65], v[152:155]
    v_rcp_f32 v151, v151
    v_mfma_f32_16x16x32_bf16 v[136:139], v[104:107], v[176:179], v[136:139]
    s_waitcnt lgkmcnt(3)
    ds_read_b128 v[160:163], v33 offset:28672
    v_cvt_pk_bf16_f32 v156, v148, v149
    v_mfma_f32_16x16x32_bf16 v[132:135], v[108:111], v[180:183], v[132:135]
    ds_read_b128 v[144:147], v22 offset:64
    v_cvt_pk_bf16_f32 v157, v150, v151
    v_mfma_f32_16x16x32_bf16 v[136:139], v[112:115], v[180:183], v[136:139]
    s_waitcnt lgkmcnt(4)
    ds_read_b128 v[164:167], v34 offset:28672
    v_rcp_f32 v152, v152
    v_mfma_f32_16x16x32_bf16 v[132:135], v[116:119], v[184:187], v[132:135]
    ds_read_b128 v[168:171], v35 offset:28672
    v_rcp_f32 v153, v153
    v_mfma_f32_16x16x32_bf16 v[136:139], v[120:123], v[184:187], v[136:139]
    s_waitcnt lgkmcnt(5)
    ds_read_b128 v[172:175], v36 offset:28672
    v_rcp_f32 v154, v154
    v_mfma_f32_16x16x32_bf16 v[132:135], v[124:127], v[188:191], v[132:135]
    v_rcp_f32 v155, v155
    v_mfma_f32_16x16x32_bf16 v[136:139], v[128:131], v[188:191], v[136:139]
    s_waitcnt lgkmcnt(4)
    v_cvt_pk_bf16_f32 v158, v152, v153
    v_cvt_pk_bf16_f32 v159, v154, v155
    v_mfma_f32_16x16x32_bf16 v[140:143], v[68:71], v[160:163], v[140:143]
    s_waitcnt lgkmcnt(3)
    ds_read_b128 v[176:179], v33 offset:36864
    v_exp_f32 v148, v132
    v_mfma_f32_16x16x32_bf16 v[52:55], v[48:51], v[156:159], v[52:55]
    v_exp_f32 v149, v133
    v_mfma_f32_16x16x32_bf16 v[144:147], v[72:75], v[160:163], v[144:147]
    s_waitcnt lgkmcnt(3)
    v_exp_f32 v150, v134
    v_mfma_f32_16x16x32_bf16 v[140:143], v[76:79], v[164:167], v[140:143]
    ds_read_b128 v[180:183], v34 offset:36864
    v_exp_f32 v151, v135
    v_mfma_f32_16x16x32_bf16 v[144:147], v[80:83], v[164:167], v[144:147]
    s_waitcnt lgkmcnt(3)
    v_exp_f32 v152, v136
    v_mfma_f32_16x16x32_bf16 v[140:143], v[84:87], v[168:171], v[140:143]
    ds_read_b128 v[184:187], v35 offset:36864
    v_exp_f32 v153, v137
    v_mfma_f32_4x4x4_16b_bf16 v[148:151], v[64:65], v[64:65], v[148:151]
    v_exp_f32 v154, v138
    v_mfma_f32_16x16x32_bf16 v[144:147], v[88:91], v[168:171], v[144:147]
    s_waitcnt lgkmcnt(3)
    ds_write_b32 v23, v52 offset:16896
    v_exp_f32 v155, v139
    v_mfma_f32_16x16x32_bf16 v[140:143], v[92:95], v[172:175], v[140:143]
    ds_read_b128 v[188:191], v36 offset:36864
    v_rcp_f32 v148, v148
    v_mfma_f32_16x16x32_bf16 v[144:147], v[96:99], v[172:175], v[144:147]
    s_waitcnt lgkmcnt(4)
    v_rcp_f32 v149, v149
    s_waitcnt lgkmcnt(0)
    s_branch L_tail3
.p2align 12
L_slow0:
    s_cmp_eq_u32 s30, 1
    s_cbranch_scc1 L_tail0
L_spin0:
    ds_read_i16 v25, v20 offset:17952
    s_sub_u32 s56, s56, 1
    s_cbranch_scc1 L_exit
    s_waitcnt lgkmcnt(0)
    v_add_co_u32 v22, vcc, v25, v21
    s_cbranch_vccnz L_spin0
    s_branch L_back0
L_slow1:
    s_cmp_eq_u32 s30, 2
    s_cbranch_scc1 L_tail1
L_spin1:
    ds_read_i16 v25, v20 offset:17984
    s_sub_u32 s56, s56, 1
    s_cbranch_scc1 L_exit
    s_waitcnt lgkmcnt(0)
    v_add_co_u32 v22, vcc, v25, v21
    s_cbranch_vccnz L_spin1
    s_branch L_back1
L_slow2:
    s_cmp_eq_u32 s30, 3
    s_cbranch_scc1 L_tail2
L_spin2:
    ds_read_i16 v25, v20 offset:18016
    s_sub_u32 s56, s56, 1
    s_cbranch_scc1 L_exit
    s_waitcnt lgkmcnt(0)
    v_add_co_u32 v22, vcc, v25, v21
    s_cbranch_vccnz L_spin2
    s_branch L_back2
L_slow3:
    s_cmp_eq_u32 s30, 4
    s_cbranch_scc1 L_tail3
L_spin3:
    ds_read_i16 v25, v20 offset:18048
    s_sub_u32 s56, s56, 1
    s_cbranch_scc1 L_exit
    s_waitcnt lgkmcnt(0)
    v_add_co_u32 v22, vcc, v25, v21
    s_cbranch_vccnz L_spin3
    s_branch L_back3
L_slow4:
    s_cmp_eq_u32 s30, 5
    s_cbranch_scc1 L_tail2
L_spin4:
    ds_read_i16 v25, v20 offset:18080
    s_sub_u32 s56, s56, 1
    s_cbranch_scc1 L_exit
    s_waitcnt lgkmcnt(0)
    v_add_co_u32 v22, vcc, v25, v21
    s_cbranch_vccnz L_spin4
    s_branch L_back4
L_slow5:
    s_cmp_eq_u32 s30, 6
    s_cbranch_scc1 L_tail3
L_spin5:
    ds_read_i16 v25, v20 offset:18112
    s_sub_u32 s56, s56, 1
    s_cbranch_scc1 L_exit
    s_waitcnt lgkmcnt(0)
    v_add_co_u32 v22, vcc, v25, v21
    s_cbranch_vccnz L_spin5
    s_branch L_back5
L_slow6:
    s_cmp_eq_u32 s30, 7
    s_cbranch_scc1 L_tail2
L_spin6:
    ds_read_i16 v25, v20 offset:18144
    s_sub_u32 s56, s56, 1
    s_cbranch_scc1 L_exit
    s_waitcnt lgkmcnt(0)
    v_add_co_u32 v22, vcc, v25, v21
    s_cbranch_vccnz L_spin6
    s_branch L_back6
L_slow7:
    s_cmp_eq_u32 s30, 8
    s_cbranch_scc1 L_tail3
L_spin7:
    ds_read_i16 v25, v20 offset:18176
    s_sub_u32 s56, s56, 1
    s_cbranch_scc1 L_exit
    s_waitcnt lgkmcnt(0)
    v_add_co_u32 v22, vcc, v25, v21
    s_cbranch_vccnz L_spin7
    s_branch L_back7
L_slow8:
    s_cmp_eq_u32 s30, 9
    s_cbranch_scc1 L_tail2
L_spin8:
    ds_read_i16 v25, v20 offset:18208
    s_sub_u32 s56, s56, 1
    s_cbranch_scc1 L_exit
    s_waitcnt lgkmcnt(0)
    v_add_co_u32 v22, vcc, v25, v21
    s_cbranch_vccnz L_spin8
    s_branch L_back8
L_slow9:
    s_cmp_eq_u32 s30, 10
    s_cbranch_scc1 L_tail3
L_spin9:
    ds_read_i16 v25, v20 offset:18240
    s_sub_u32 s56, s56, 1
    s_cbranch_scc1 L_exit
    s_waitcnt lgkmcnt(0)
    v_add_co_u32 v22, vcc, v25, v21
    s_cbranch_vccnz L_spin9
    s_branch L_back9
L_slow10:
    s_cmp_eq_u32 s30, 11
    s_cbranch_scc1 L_tail2
L_spin10:
    ds_read_i16 v25, v20 offset:18272
    s_sub_u32 s56, s56, 1
    s_cbranch_scc1 L_exit
    s_waitcnt lgkmcnt(0)
    v_add_co_u32 v22, vcc, v25, v21
    s_cbranch_vccnz L_spin10
    s_branch L_back10
L_slow11:
    s_cmp_eq_u32 s30, 12
    s_cbranch_scc1 L_tail3
L_spin11:
    ds_read_i16 v25, v20 offset:18304
    s_sub_u32 s56, s56, 1
    s_cbranch_scc1 L_exit
    s_waitcnt lgkmcnt(0)
    v_add_co_u32 v22, vcc, v25, v21
    s_cbranch_vccnz L_spin11
    s_branch L_back11
L_slow12:
    s_cmp_eq_u32 s30, 13
    s_cbranch_scc1 L_tail2
L_spin12:
    ds_read_i16 v25, v20 offset:18336
    s_sub_u32 s56, s56, 1
    s_cbranch_scc1 L_exit
    s_waitcnt lgkmcnt(0)
    v_add_co_u32 v22, vcc, v25, v21
    s_cbranch_vccnz L_spin12
    s_branch L_back12
L_slow13:
    s_cmp_eq_u32 s30, 14
    s_cbranch_scc1 L_tail3
L_spin13:
    ds_read_i16 v25, v20 offset:18368
    s_sub_u32 s56, s56, 1
    s_cbranch_scc1 L_exit
    s_waitcnt lgkmcnt(0)
    v_add_co_u32 v22, vcc, v25, v21
    s_cbranch_vccnz L_spin13
    s_branch L_back13
L_tail3:
    v_mfma_f32_16x16x32_bf16 v[140:143], v[100:103], v[176:179], v[140:143]
    s_waitcnt lgkmcnt(3)
    v_rcp_f32 v150, v150
    v_cvt_pk_bf16_f32 v156, v148, v149
    v_mfma_f32_4x4x4_16b_bf16 v[152:155], v[64:65], v[64:65], v[152:155]
    v_rcp_f32 v151, v151
    v_mfma_f32_16x16x32_bf16 v[140:143], v[108:111], v[180:183], v[140:143]
    s_waitcnt lgkmcnt(2)
    v_cvt_pk_bf16_f32 v157, v150, v151
    v_mfma_f32_16x16x32_bf16 v[140:143], v[116:119], v[184:187], v[140:143]
    s_waitcnt lgkmcnt(0)
    v_rcp_f32 v152, v152
    v_mfma_f32_16x16x32_bf16 v[140:143], v[124:127], v[188:191], v[140:143]
    v_rcp_f32 v153, v153
    v_mfma_f32_16x16x32_bf16 v[144:147], v[104:107], v[176:179], v[144:147]
    v_rcp_f32 v154, v154
    v_mfma_f32_16x16x32_bf16 v[144:147], v[112:115], v[180:183], v[144:147]
    v_rcp_f32 v155, v155
    v_mfma_f32_16x16x32_bf16 v[144:147], v[120:123], v[184:187], v[144:147]
    v_cvt_pk_bf16_f32 v158, v152, v153
    v_cvt_pk_bf16_f32 v159, v154, v155
    v_mfma_f32_16x16x32_bf16 v[144:147], v[128:131], v[188:191], v[144:147]
    v_exp_f32 v148, v140
    v_mfma_f32_16x16x32_bf16 v[52:55], v[44:47], v[156:159], v[60:63]
    v_exp_f32 v149, v141
    v_exp_f32 v150, v142
    v_exp_f32 v151, v143
    s_nop 1
    v_mfma_f32_4x4x4_16b_bf16 v[148:151], v[64:65], v[64:65], v[148:151]
    v_exp_f32 v152, v144
    v_exp_f32 v153, v145
    v_exp_f32 v154, v146
    v_exp_f32 v155, v147
    s_nop 0
    v_rcp_f32 v148, v148
    v_rcp_f32 v149, v149
    v_mfma_f32_4x4x4_16b_bf16 v[152:155], v[64:65], v[64:65], v[152:155]
    v_rcp_f32 v150, v150
    v_rcp_f32 v151, v151
    v_cvt_pk_bf16_f32 v156, v148, v149
    v_cvt_pk_bf16_f32 v157, v150, v151
    s_nop 0
    v_rcp_f32 v152, v152
    v_rcp_f32 v153, v153
    v_rcp_f32 v154, v154
    v_rcp_f32 v155, v155
    v_cvt_pk_bf16_f32 v158, v152, v153
    v_cvt_pk_bf16_f32 v159, v154, v155
    s_nop 1
    v_mfma_f32_16x16x32_bf16 v[52:55], v[48:51], v[156:159], v[52:55]
    s_nop 7
    ds_write_b32 v24, v52 offset:12288
    s_waitcnt lgkmcnt(0)
    s_barrier
    s_endpgm
L_tail2:
    v_mfma_f32_16x16x32_bf16 v[132:135], v[100:103], v[176:179], v[132:135]
    s_waitcnt lgkmcnt(2)
    v_rcp_f32 v150, v150
    v_cvt_pk_bf16_f32 v156, v148, v149
    v_mfma_f32_4x4x4_16b_bf16 v[152:155], v[64:65], v[64:65], v[152:155]
    v_rcp_f32 v151, v151
    v_mfma_f32_16x16x32_bf16 v[132:135], v[108:111], v[180:183], v[132:135]
    s_waitcnt lgkmcnt(1)
    v_cvt_pk_bf16_f32 v157, v150, v151
    v_mfma_f32_16x16x32_bf16 v[132:135], v[116:119], v[184:187], v[132:135]
    s_waitcnt lgkmcnt(0)
    v_rcp_f32 v152, v152
    v_mfma_f32_16x16x32_bf16 v[132:135], v[124:127], v[188:191], v[132:135]
    v_rcp_f32 v153, v153
    v_mfma_f32_16x16x32_bf16 v[136:139], v[104:107], v[176:179], v[136:139]
    v_rcp_f32 v154, v154
    v_mfma_f32_16x16x32_bf16 v[136:139], v[112:115], v[180:183], v[136:139]
    v_rcp_f32 v155, v155
    v_mfma_f32_16x16x32_bf16 v[136:139], v[120:123], v[184:187], v[136:139]
    v_cvt_pk_bf16_f32 v158, v152, v153
    v_cvt_pk_bf16_f32 v159, v154, v155
    v_mfma_f32_16x16x32_bf16 v[136:139], v[128:131], v[188:191], v[136:139]
    v_exp_f32 v148, v132
    v_mfma_f32_16x16x32_bf16 v[52:55], v[48:51], v[156:159], v[52:55]
    v_exp_f32 v149, v133
    v_exp_f32 v150, v134
    v_exp_f32 v151, v135
    s_nop 1
    v_mfma_f32_4x4x4_16b_bf16 v[148:151], v[64:65], v[64:65], v[148:151]
    v_exp_f32 v152, v136
    v_exp_f32 v153, v137
    v_exp_f32 v154, v138
    v_exp_f32 v155, v139
    s_nop 0
    v_rcp_f32 v148, v148
    v_rcp_f32 v149, v149
    v_mfma_f32_4x4x4_16b_bf16 v[152:155], v[64:65], v[64:65], v[152:155]
    v_rcp_f32 v150, v150
    v_rcp_f32 v151, v151
    ds_write_b32 v24, v52 offset:11776
    v_cvt_pk_bf16_f32 v156, v148, v149
    v_cvt_pk_bf16_f32 v157, v150, v151
    v_rcp_f32 v152, v152
    v_rcp_f32 v153, v153
    v_rcp_f32 v154, v154
    v_rcp_f32 v155, v155
    v_cvt_pk_bf16_f32 v158, v152, v153
    v_cvt_pk_bf16_f32 v159, v154, v155
    s_nop 1
    v_mfma_f32_16x16x32_bf16 v[56:59], v[44:47], v[156:159], v[60:63]
    s_nop 7
    ds_write_b32 v24, v56 offset:12288
    s_waitcnt lgkmcnt(0)
    s_barrier
    s_endpgm
L_fin:
    s_setprio 0
    s_waitcnt vmcnt(0)
    ds_write_b16 v22, v8 offset:18592
    s_cmp_eq_u32 s48, 0
    s_cbranch_scc1 L_early_done
L_rwait:
    ds_read_i16 v13, v33 offset:17920
    s_sub_u32 s56, s56, 1
    s_cbranch_scc1 L_exit
    s_waitcnt lgkmcnt(0)
    v_cmp_gt_i32 vcc, 0, v13
    s_cbranch_vccnz L_rwait
    ds_read_b64 v[156:157], v25 offset:18944
    ds_read_b64 v[158:159], v25 offset:18976
    ds_read_b64_tr_b16 v[84:85], v38 offset:0
    ds_read_b64_tr_b16 v[86:87], v39 offset:256
    ds_read_b64_tr_b16 v[88:89], v40 offset:0
    ds_read_b64_tr_b16 v[90:91], v41 offset:256
    ds_read_b64_tr_b16 v[92:93], v38 offset:8192
    ds_read_b64_tr_b16 v[94:95], v39 offset:8448
    ds_read_b64_tr_b16 v[96:97], v40 offset:8192
    ds_read_b64_tr_b16 v[98:99], v41 offset:8448
    ds_read_b64_tr_b16 v[100:101], v38 offset:16384
    ds_read_b64_tr_b16 v[102:103], v39 offset:16640
    ds_read_b64_tr_b16 v[104:105], v40 offset:16384
    ds_read_b64_tr_b16 v[106:107], v41 offset:16640
    ds_read_b64_tr_b16 v[108:109], v38 offset:24576
    ds_read_b64_tr_b16 v[110:111], v39 offset:24832
    ds_read_b64_tr_b16 v[112:113], v40 offset:24576
    ds_read_b64_tr_b16 v[114:115], v41 offset:24832
    s_sub_u32 s44, s48, 1
    s_min_u32 s44, s44, 3
    v_lshl_add_u32 v12, s44, 9, v28
L_pw:
    ds_read_b32 v13, v12 offset:12800
    s_sub_u32 s56, s56, 1
    s_cbranch_scc1 L_exit
    s_waitcnt lgkmcnt(0)
    v_cmp_eq_u32 vcc, -1, v13
    s_cbranch_vccnz L_pw
    ds_read_b128 v[148:151], v24 offset:12800
    ds_read_b128 v[152:155], v24 offset:13824
    s_waitcnt lgkmcnt(0)
    v_add_f32 v148, v148, v149
    v_add_f32 v150, v150, v151
    v_add_f32 v152, v152, v153
    v_add_f32 v154, v154, v155
    v_add_f32 v148, v148, v150
    v_add_f32 v152, v152, v154
    v_mul_f32 v148, v148, v157
    v_mul_f32 v152, v152, v159
    v_cvt_pk_bf16_f32 v148, v148, v148
    v_cvt_pk_bf16_f32 v152, v152, v152
    ds_write_b16 v156, v148 offset:22016
    ds_write_b16 v158, v152 offset:22016
    ds_read_b128 v[132:135], v23 offset:22016
    ds_read_b128 v[136:139], v23 offset:22080
    ds_read_b128 v[140:143], v23 offset:22144
    ds_read_b128 v[144:147], v23 offset:22208
    s_setprio 2
    s_cmp_le_u32 s48, 1
    s_waitcnt lgkmcnt(3)
    v_mfma_f32_16x16x32_bf16 v[192:195], v[84:87], v[132:135], v[192:195]
    v_mfma_f32_16x16x32_bf16 v[196:199], v[88:91], v[132:135], v[196:199]
    s_cbranch_scc1 L_early_done
    s_cmp_le_u32 s48, 2
    s_waitcnt lgkmcnt(2)
    v_mfma_f32_16x16x32_bf16 v[192:195], v[92:95], v[136:139], v[192:195]
    v_mfma_f32_16x16x32_bf16 v[196:199], v[96:99], v[136:139], v[196:199]
    s_cbranch_scc1 L_early_done
    s_cmp_le_u32 s48, 3
    s_waitcnt lgkmcnt(1)
    v_mfma_f32_16x16x32_bf16 v[192:195], v[100:103], v[140:143], v[192:195]
    v_mfma_f32_16x16x32_bf16 v[196:199], v[104:107], v[140:143], v[196:199]
    s_cbranch_scc1 L_early_done
    s_cmp_le_u32 s48, 4
    s_waitcnt lgkmcnt(0)
    v_mfma_f32_16x16x32_bf16 v[192:195], v[108:111], v[144:147], v[192:195]
    v_mfma_f32_16x16x32_bf16 v[196:199], v[112:115], v[144:147], v[196:199]
    s_cbranch_scc0 L_more
L_early_done:
    s_setprio 0
L_fwait:
    ds_read_i16 v13, v32 offset:18592
    s_sub_u32 s56, s56, 1
    s_cbranch_scc1 L_exit
    s_waitcnt lgkmcnt(0)
    v_cmp_gt_i32 vcc, 0, v13
    s_cbranch_vccnz L_fwait
    ds_read_b64 v[160:161], v31 offset:18944
    ds_read_b64_tr_b16 v[116:117], v42 offset:0
    ds_read_b64_tr_b16 v[118:119], v43 offset:256
    ds_read_b64_tr_b16 v[120:121], v44 offset:0
    ds_read_b64_tr_b16 v[122:123], v45 offset:256
    ds_read_b64_tr_b16 v[124:125], v42 offset:8192
    ds_read_b64_tr_b16 v[126:127], v43 offset:8448
    ds_read_b64_tr_b16 v[128:129], v44 offset:8192
    ds_read_b64_tr_b16 v[130:131], v45 offset:8448
    s_cmp_le_u32 s30, 2
    s_setprio 2
    s_barrier
    ds_read_b128 v[148:151], v29 offset:12800
    s_waitcnt lgkmcnt(0)
    v_add_f32 v148, v148, v149
    v_add_f32 v150, v150, v151
    v_add_f32 v148, v148, v150
    v_mul_f32 v148, v148, v161
    v_cvt_pk_bf16_f32 v148, v148, v148
    ds_write_b16 v160, v148 offset:22016
    ds_read_b128 v[132:135], v30 offset:22016
    ds_read_b128 v[136:139], v30 offset:22080
    s_waitcnt lgkmcnt(1)
    v_mfma_f32_16x16x32_bf16 v[192:195], v[116:119], v[132:135], v[192:195]
    v_mfma_f32_16x16x32_bf16 v[196:199], v[120:123], v[132:135], v[196:199]
    s_cbranch_scc1 L_store
    s_waitcnt lgkmcnt(0)
    v_mfma_f32_16x16x32_bf16 v[192:195], v[124:127], v[136:139], v[192:195]
    v_mfma_f32_16x16x32_bf16 v[196:199], v[128:131], v[136:139], v[196:199]
L_store:
    s_nop 6
    v_cvt_pk_bf16_f32 v180, v192, v193
    v_cvt_pk_bf16_f32 v181, v194, v195
    ds_write_b64 v252, v[180:181] offset:32512
    v_cvt_pk_bf16_f32 v182, v196, v197
    v_cvt_pk_bf16_f32 v183, v198, v199
    ds_write_b64 v253, v[182:183] offset:32512
    ds_read_b128 v[180:183], v36 offset:32512
    s_waitcnt lgkmcnt(0)
    global_store_dwordx4 v27, v[180:183], s[18:19]
    s_endpgm
L_more:
    s_mov_b32 s53, 4
    s_sub_u32 s44, s48, 1
    v_lshl_add_u32 v12, s44, 9, v28
L_pwm:
    ds_read_b32 v13, v12 offset:12800
    s_sub_u32 s56, s56, 1
    s_cbranch_scc1 L_exit
    s_waitcnt lgkmcnt(0)
    v_cmp_eq_u32 vcc, -1, v13
    s_cbranch_vccnz L_pwm
L_more_loop:
    v_lshl_add_u32 v180, s53, 13, v38
    v_lshl_add_u32 v181, s53, 13, v39
    v_lshl_add_u32 v182, s53, 13, v40
    v_lshl_add_u32 v183, s53, 13, v41
    v_lshl_add_u32 v184, s53, 9, v24
    v_lshl_add_u32 v185, s53, 4, v25
    v_lshl_add_u32 v186, s53, 6, v23
    ds_read_b128 v[148:151], v184 offset:12800
    ds_read_b64 v[156:157], v185 offset:18944
    s_waitcnt lgkmcnt(1)
    v_add_f32 v148, v148, v149
    v_add_f32 v150, v150, v151
    v_add_f32 v148, v148, v150
    s_waitcnt lgkmcnt(0)
    v_mul_f32 v148, v148, v157
    v_cvt_pk_bf16_f32 v148, v148, v148
    ds_write_b16 v156, v148 offset:22016
    ds_read_b128 v[132:135], v186 offset:22016
    ds_read_b64_tr_b16 v[84:85], v180 offset:0
    ds_read_b64_tr_b16 v[86:87], v181 offset:256
    ds_read_b64_tr_b16 v[88:89], v182 offset:0
    ds_read_b64_tr_b16 v[90:91], v183 offset:256
    s_add_u32 s53, s53, 1
    s_cmp_lt_u32 s53, s48
    s_waitcnt lgkmcnt(2)
    v_mfma_f32_16x16x32_bf16 v[192:195], v[84:87], v[132:135], v[192:195]
    s_waitcnt lgkmcnt(0)
    v_mfma_f32_16x16x32_bf16 v[196:199], v[88:91], v[132:135], v[196:199]
    s_cbranch_scc1 L_more_loop
    s_branch L_early_done
L_slow14:
    s_cmp_eq_u32 s30, 15
    s_cbranch_scc1 L_tail2
L_spin14:
    ds_read_i16 v25, v20 offset:18400
    s_sub_u32 s56, s56, 1
    s_cbranch_scc1 L_exit
    s_waitcnt lgkmcnt(0)
    v_add_co_u32 v22, vcc, v25, v21
    s_cbranch_vccnz L_spin14
    s_branch L_back14
L_slow15:
    s_cmp_eq_u32 s30, 16
    s_cbranch_scc1 L_tail3
L_spin15:
    ds_read_i16 v25, v20 offset:18432
    s_sub_u32 s56, s56, 1
    s_cbranch_scc1 L_exit
    s_waitcnt lgkmcnt(0)
    v_add_co_u32 v22, vcc, v25, v21
    s_cbranch_vccnz L_spin15
    s_branch L_back15
L_slow16:
    s_cmp_eq_u32 s30, 17
    s_cbranch_scc1 L_tail2
L_spin16:
    ds_read_i16 v25, v20 offset:18464
    s_sub_u32 s56, s56, 1
    s_cbranch_scc1 L_exit
    s_waitcnt lgkmcnt(0)
    v_add_co_u32 v22, vcc, v25, v21
    s_cbranch_vccnz L_spin16
    s_branch L_back16
L_slow17:
    s_cmp_eq_u32 s30, 18
    s_cbranch_scc1 L_tail3
L_spin17:
    ds_read_i16 v25, v20 offset:18496
    s_sub_u32 s56, s56, 1
    s_cbranch_scc1 L_exit
    s_waitcnt lgkmcnt(0)
    v_add_co_u32 v22, vcc, v25, v21
    s_cbranch_vccnz L_spin17
    s_branch L_back17
L_slow18:
    s_cmp_eq_u32 s30, 19
    s_cbranch_scc1 L_tail2
L_spin18:
    ds_read_i16 v25, v20 offset:18528
    s_sub_u32 s56, s56, 1
    s_cbranch_scc1 L_exit
    s_waitcnt lgkmcnt(0)
    v_add_co_u32 v22, vcc, v25, v21
    s_cbranch_vccnz L_spin18
    s_branch L_back18
L_tail1:
    v_mfma_f32_16x16x32_bf16 v[140:143], v[116:119], v[184:187], v[140:143]
    v_mfma_f32_16x16x32_bf16 v[144:147], v[120:123], v[184:187], v[144:147]
    s_waitcnt lgkmcnt(0)
    v_mfma_f32_16x16x32_bf16 v[140:143], v[124:127], v[188:191], v[140:143]
    v_mfma_f32_16x16x32_bf16 v[144:147], v[128:131], v[188:191], v[144:147]
    v_mfma_f32_16x16x32_bf16 v[52:55], v[44:47], v[156:159], v[60:63]
    s_nop 5
    v_exp_f32 v148, v140
    v_exp_f32 v149, v141
    v_exp_f32 v150, v142
    v_exp_f32 v151, v143
    v_exp_f32 v152, v144
    v_exp_f32 v153, v145
    v_mfma_f32_4x4x4_16b_bf16 v[148:151], v[64:65], v[64:65], v[148:151]
    v_exp_f32 v154, v146
    v_exp_f32 v155, v147
    s_nop 1
    v_mfma_f32_4x4x4_16b_bf16 v[152:155], v[64:65], v[64:65], v[152:155]
    v_rcp_f32 v148, v148
    v_rcp_f32 v149, v149
    v_rcp_f32 v150, v150
    v_rcp_f32 v151, v151
    v_cvt_pk_bf16_f32 v156, v148, v149
    v_rcp_f32 v152, v152
    v_rcp_f32 v153, v153
    v_cvt_pk_bf16_f32 v157, v150, v151
    v_rcp_f32 v154, v154
    v_rcp_f32 v155, v155
    v_cvt_pk_bf16_f32 v158, v152, v153
    v_cvt_pk_bf16_f32 v159, v154, v155
    s_nop 1
    v_mfma_f32_16x16x32_bf16 v[52:55], v[48:51], v[156:159], v[52:55]
    s_nop 7
    ds_write_b32 v24, v52 offset:12288
    s_waitcnt lgkmcnt(0)
    s_barrier
    s_endpgm
L_tail0:
    v_rcp_f32 v149, v149
    v_rcp_f32 v150, v150
    v_rcp_f32 v151, v151
    v_cvt_pk_bf16_f32 v156, v148, v149
    v_rcp_f32 v152, v152
    v_rcp_f32 v153, v153
    v_cvt_pk_bf16_f32 v157, v150, v151
    v_rcp_f32 v154, v154
    v_rcp_f32 v155, v155
    v_cvt_pk_bf16_f32 v158, v152, v153
    v_cvt_pk_bf16_f32 v159, v154, v155
    s_nop 1
    v_mfma_f32_16x16x32_bf16 v[56:59], v[44:47], v[156:159], v[60:63]
    s_nop 7
    ds_write_b32 v24, v56 offset:12288
    s_waitcnt lgkmcnt(0)
    s_barrier
    s_endpgm
.p2align 12
L_h3:
    s_add_u32 s48, s30, 1
    s_lshr_b32 s48, s48, 1
    s_max_u32 s48, s48, 2
    s_sub_u32 s48, s48, 2
    s_sub_u32 s49, s30, 1
    s_min_u32 s49, s49, 7
    s_lshl_b32 s49, s49, 5
    s_mov_b32 s16, 0x10001
    s_mov_b32 s17, s16
    s_mul_i32 s44, s29, 6
    s_lshr_b64 s[12:13], s[32:33], s44
    s_and_b32 s12, s12, 63
    s_lshl_b32 s44, s44, 8
    s_add_u32 s44, s44, s28
    s_add_u32 s14, s6, s44
    s_addc_u32 s15, s7, 0
    v_lshl_add_u32 v188, v189, 8, v188
    v_and_b32 v189, 1, v0
    v_lshl_add_u32 v188, v189, 3, v188
    v_add_u32 v38, 48896, v188
    v_xor_b32 v39, 16, v38
    v_xor_b32 v40, 32, v38
    v_xor_b32 v41, 48, v38
    v_mul_u32_u24 v188, 656, v2
    v_lshl_add_u32 v23, v3, 4, v188
    v_lshlrev_b32 v24, 4, v1
    v_mul_u32_u24 v188, 160, v2
    v_lshl_add_u32 v25, v3, 3, v188
    v_lshlrev_b32 v28, 2, v7
    v_and_b32 v188, 0xf8, v15
    v_and_b32 v189, 1, v15
    v_lshl_or_b32 v188, v189, 2, v188
    s_setprio 2
    s_waitcnt vmcnt(0)
    s_barrier
    s_add_u32 m0, s31, 65536
    s_mov_b32 s45, 32768
    buffer_load_dwordx4 v10, s[24:27], s45 offen  lds
    v_subrev_u32 v13, s42, v14
    v_xor_b32_dpp v180, v18, v20 row_newbcast:0 row_mask:0xf bank_mask:0xf
    v_xor_b32_dpp v181, v18, v20 row_newbcast:1 row_mask:0xf bank_mask:0xf
    v_xor_b32_dpp v182, v18, v20 row_newbcast:2 row_mask:0xf bank_mask:0xf
    ds_read_b128 v[200:203], v180 offset:8704
    ds_read_b128 v[204:207], v181 offset:8704
    ds_read_b128 v[208:211], v182 offset:8704
    ds_read_u16 v35, v13 offset:18944
    s_add_u32 m0, s31, 66560
    s_mov_b32 s45, 36864
    buffer_load_dwordx4 v10, s[24:27], s45 offen  lds
    v_xor_b32_dpp v180, v18, v20 row_newbcast:3 row_mask:0xf bank_mask:0xf
    v_xor_b32_dpp v181, v18, v20 row_newbcast:4 row_mask:0xf bank_mask:0xf
    v_xor_b32_dpp v182, v18, v20 row_newbcast:5 row_mask:0xf bank_mask:0xf
    ds_read_b128 v[212:215], v180 offset:8704
    ds_read_b128 v[216:219], v181 offset:8704
    ds_read_b128 v[220:223], v182 offset:8704
    s_add_u32 m0, s31, 67584
    s_mov_b32 s45, 40960
    buffer_load_dwordx4 v10, s[24:27], s45 offen  lds
    v_xor_b32_dpp v180, v18, v20 row_newbcast:6 row_mask:0xf bank_mask:0xf
    v_xor_b32_dpp v181, v18, v20 row_newbcast:7 row_mask:0xf bank_mask:0xf
    v_xor_b32_dpp v182, v18, v20 row_newbcast:8 row_mask:0xf bank_mask:0xf
    ds_read_b128 v[224:227], v180 offset:8704
    ds_read_b128 v[228:231], v181 offset:8704
    ds_read_b128 v[232:235], v182 offset:8704
    s_add_u32 m0, s31, 68608
    s_mov_b32 s45, 45056
    buffer_load_dwordx4 v10, s[24:27], s45 offen  lds
    v_xor_b32_dpp v180, v18, v20 row_newbcast:9 row_mask:0xf bank_mask:0xf
    v_xor_b32_dpp v181, v18, v20 row_newbcast:10 row_mask:0xf bank_mask:0xf
    v_xor_b32_dpp v182, v18, v20 row_newbcast:11 row_mask:0xf bank_mask:0xf
    ds_read_b128 v[236:239], v180 offset:8704
    ds_read_b128 v[240:243], v181 offset:8704
    ds_read_b128 v[244:247], v182 offset:8704
    s_add_u32 m0, s31, 69632
    s_mov_b32 s45, 49152
    buffer_load_dwordx4 v10, s[24:27], s45 offen  lds
    s_waitcnt lgkmcnt(0)
    s_ff1_i32_b32 s44, s12
    s_bitset0_b32 s12, s44
    s_max_i32 s44, s44, 0
    s_lshl_b32 s44, s44, 8
    s_load_dword s10, s[14:15], s44 offset:0
    s_load_dword s10, s[14:15], s44 offset:64
    s_load_dword s10, s[14:15], s44 offset:128
    s_load_dword s10, s[14:15], s44 offset:192
    s_add_u32 m0, s31, 70656
    s_mov_b32 s45, 53248
    buffer_load_dwordx4 v10, s[24:27], s45 offen  lds
    s_ff1_i32_b32 s44, s12
    s_bitset0_b32 s12, s44
    s_max_i32 s44, s44, 0
    s_lshl_b32 s44, s44, 8
    s_load_dword s10, s[14:15], s44 offset:0
    s_load_dword s10, s[14:15], s44 offset:64
    s_load_dword s10, s[14:15], s44 offset:128
    s_load_dword s10, s[14:15], s44 offset:192
    s_add_u32 m0, s31, 71680
    s_mov_b32 s45, 57344
    buffer_load_dwordx4 v10, s[24:27], s45 offen  lds
    s_ff1_i32_b32 s44, s12
    s_bitset0_b32 s12, s44
    s_max_i32 s44, s44, 0
    s_lshl_b32 s44, s44, 8
    s_load_dword s10, s[14:15], s44 offset:0
    s_load_dword s10, s[14:15], s44 offset:64
    s_load_dword s10, s[14:15], s44 offset:128
    s_load_dword s10, s[14:15], s44 offset:192
    s_add_u32 m0, s31, 72704
    s_mov_b32 s45, 61440
    buffer_load_dwordx4 v10, s[24:27], s45 offen  lds
    v_add_u32_dpp v46, v16, v20 row_newbcast:0 row_mask:0xf bank_mask:0xf
    v_add_u32_dpp v47, v16, v20 row_newbcast:1 row_mask:0xf bank_mask:0xf
    v_add_u32_dpp v48, v16, v20 row_newbcast:2 row_mask:0xf bank_mask:0xf
    v_add_u32_dpp v49, v16, v20 row_newbcast:3 row_mask:0xf bank_mask:0xf
    s_add_u32 m0, s31, 73728
    s_mov_b32 s45, 98304
    buffer_load_dwordx4 v10, s[24:27], s45 offen  lds
    v_add_u32_dpp v50, v16, v20 row_newbcast:4 row_mask:0xf bank_mask:0xf
    v_add_u32_dpp v51, v16, v20 row_newbcast:5 row_mask:0xf bank_mask:0xf
    v_add_u32_dpp v52, v16, v20 row_newbcast:6 row_mask:0xf bank_mask:0xf
    v_add_u32_dpp v53, v16, v20 row_newbcast:7 row_mask:0xf bank_mask:0xf
    s_add_u32 m0, s31, 74752
    s_mov_b32 s45, 102400
    buffer_load_dwordx4 v10, s[24:27], s45 offen  lds
    v_add_u32_dpp v54, v16, v20 row_newbcast:8 row_mask:0xf bank_mask:0xf
    v_add_u32_dpp v55, v16, v20 row_newbcast:9 row_mask:0xf bank_mask:0xf
    v_add_u32_dpp v56, v16, v20 row_newbcast:10 row_mask:0xf bank_mask:0xf
    v_add_u32_dpp v57, v16, v20 row_newbcast:11 row_mask:0xf bank_mask:0xf
    s_add_u32 m0, s31, 75776
    s_mov_b32 s45, 106496
    buffer_load_dwordx4 v10, s[24:27], s45 offen  lds
    v_add_u32_dpp v58, v16, v20 row_newbcast:12 row_mask:0xf bank_mask:0xf
    v_add_u32_dpp v59, v16, v20 row_newbcast:13 row_mask:0xf bank_mask:0xf
    v_bfe_u32 v189, v15, 1, 2
    v_or_b32 v188, v188, v189
    s_add_u32 m0, s31, 76800
    s_mov_b32 s45, 110592
    buffer_load_dwordx4 v10, s[24:27], s45 offen  lds
    v_lshlrev_b32 v26, 1, v188
    v_bfe_u32 v188, v0, 1, 2
    v_lshlrev_b32 v188, 1, v188
    v_xor_b32 v188, v188, v3
    s_add_u32 m0, s31, 77824
    s_mov_b32 s45, 114688
    buffer_load_dwordx4 v10, s[24:27], s45 offen  lds
    v_lshlrev_b32 v188, 3, v188
    v_lshl_add_u32 v188, v2, 6, v188
    v_lshl_add_u32 v252, s29, 10, v188
    v_xor_b32 v253, 32, v252
    s_add_u32 m0, s31, 78848
    s_mov_b32 s45, 118784
    buffer_load_dwordx4 v10, s[24:27], s45 offen  lds
    v_bfe_u32 v188, v0, 3, 2
    v_xor_b32 v188, v188, v7
    v_lshlrev_b32 v188, 4, v188
    v_lshrrev_b32 v189, 2, v1
    s_add_u32 m0, s31, 79872
    s_mov_b32 s45, 122880
    buffer_load_dwordx4 v10, s[24:27], s45 offen  lds
    v_lshl_add_u32 v188, v189, 8, v188
    v_lshl_add_u32 v188, s29, 6, v188
    v_lshl_add_u32 v27, s2, 12, v188
    v_mov_b32 v192, 0
    s_add_u32 m0, s31, 80896
    s_mov_b32 s45, 126976
    buffer_load_dwordx4 v10, s[24:27], s45 offen  lds
    s_waitcnt vmcnt(8)
    s_barrier
    s_setprio 0
    s_add_u32 m0, s57, 0
    buffer_load_dwordx4 v[60:63], v46, s[20:23], 0 offen nt
    v_mov_b32 v193, 0
    v_mov_b32 v194, 0
    v_mov_b32 v195, 0
    v_mov_b32 v196, 0
    v_mov_b32 v197, 0
    v_mov_b32 v198, 0
    v_mov_b32 v199, 0
    buffer_load_dwordx4 v46, s[20:23], 0 offen nt lds
    v_add_u32 v34, v19, v26
    v_cndmask_b32 v35, 0, v35, s[58:59]
    v_lshrrev_b32 v12, 4, v0
    v_lshlrev_b32 v35, 16, v35
    v_mul_u32_u24 v12, 160, v12
    v_lshl_add_u32 v12, v2, 3, v12
    v_lshl_add_u32 v42, s48, 13, v38
    s_add_u32 m0, s57, 4096
    buffer_load_dwordx4 v[64:67], v47, s[20:23], 0 offen nt
    v_lshl_add_u32 v43, s48, 13, v39
    v_lshl_add_u32 v44, s48, 13, v40
    v_lshl_add_u32 v45, s48, 13, v41
    v_lshl_add_u32 v31, s48, 4, v25
    v_lshl_add_u32 v29, s48, 9, v24
    v_lshl_add_u32 v30, s48, 6, v23
    v_lshl_add_u32 v33, v2, 1, s49
    buffer_load_dwordx4 v47, s[20:23], 0 offen nt lds
    v_mfma_f32_4x4x4_16b_bf16 v[84:87], v[250:251], v[200:201], 0
    v_mfma_f32_4x4x4_16b_bf16 v[88:91], v[250:251], v[202:203], 0
    v_mfma_f32_4x4x4_16b_bf16 v[92:95], v[250:251], v[204:205], 0
    v_mfma_f32_4x4x4_16b_bf16 v[96:99], v[250:251], v[206:207], 0
    v_mfma_f32_4x4x4_16b_bf16 v[100:103], v[250:251], v[208:209], 0
    v_mfma_f32_4x4x4_16b_bf16 v[104:107], v[250:251], v[210:211], 0
    v_mfma_f32_4x4x4_16b_bf16 v[108:111], v[250:251], v[212:213], 0
    s_add_u32 m0, s57, 8192
    buffer_load_dwordx4 v[68:71], v48, s[20:23], 0 offen nt
    v_mfma_f32_4x4x4_16b_bf16 v[112:115], v[250:251], v[214:215], 0
    v_mfma_f32_4x4x4_16b_bf16 v[116:119], v[250:251], v[216:217], 0
    v_mfma_f32_4x4x4_16b_bf16 v[120:123], v[250:251], v[218:219], 0
    v_mfma_f32_4x4x4_16b_bf16 v[124:127], v[250:251], v[220:221], 0
    v_mfma_f32_4x4x4_16b_bf16 v[128:131], v[250:251], v[222:223], 0
    v_mfma_f32_4x4x4_16b_bf16 v[132:135], v[250:251], v[224:225], 0
    v_mfma_f32_4x4x4_16b_bf16 v[136:139], v[250:251], v[226:227], 0
    buffer_load_dwordx4 v48, s[20:23], 0 offen nt lds
    v_mfma_f32_4x4x4_16b_bf16 v[140:143], v[250:251], v[228:229], 0
    v_mfma_f32_4x4x4_16b_bf16 v[144:147], v[250:251], v[230:231], 0
    v_mfma_f32_4x4x4_16b_bf16 v[148:151], v[250:251], v[232:233], 0
    v_mfma_f32_4x4x4_16b_bf16 v[152:155], v[250:251], v[234:235], 0
    v_mfma_f32_4x4x4_16b_bf16 v[156:159], v[250:251], v[236:237], 0
    v_mfma_f32_4x4x4_16b_bf16 v[160:163], v[250:251], v[238:239], 0
    v_mfma_f32_4x4x4_16b_bf16 v[164:167], v[250:251], v[240:241], 0
    s_setprio 2
    v_mov_b32 v188, s30
    s_waitcnt vmcnt(6)
    s_barrier
    v_mfma_f32_4x4x4_16b_bf16 v[168:171], v[250:251], v[242:243], 0
    v_mfma_f32_4x4x4_16b_bf16 v[172:175], v[250:251], v[244:245], 0
    v_mfma_f32_4x4x4_16b_bf16 v[176:179], v[250:251], v[246:247], 0
    ds_write_b16 v22, v188 offset:18576
    ds_write_b64 v12, v[34:35] offset:18944
    s_add_u32 m0, s57, 12288
    buffer_load_dwordx4 v[72:75], v49, s[20:23], 0 offen nt
    buffer_load_dwordx4 v49, s[20:23], 0 offen nt lds
    s_waitcnt vmcnt(7)
    v_mfma_f32_4x4x4_16b_bf16 v[180:183], v[248:249], v[60:61], 0
    v_mfma_f32_4x4x4_16b_bf16 v[184:187], v[248:249], v[62:63], 0
    s_nop 3
    v_mul_f32 v180, v180, v84
    v_mul_f32 v181, v181, v85
    v_mul_f32 v182, v182, v86
    v_mul_f32 v183, v183, v87
    v_mul_f32 v184, v184, v88
    v_mul_f32 v185, v185, v89
    v_mul_f32 v186, v186, v90
    v_mul_f32 v187, v187, v91
    v_cvt_pk_bf16_f32 v188, v180, v181
    v_cvt_pk_bf16_f32 v189, v182, v183
    v_cvt_pk_bf16_f32 v190, v184, v185
    v_cvt_pk_bf16_f32 v191, v186, v187
    ds_write_b128 v36, v[188:191] offset:32512
    s_mov_b64 exec, s[16:17]
    s_waitcnt vmcnt(6)
    ds_write_b16 v21, v17 offset:17920
    s_mov_b64 exec, -1
    s_lshl_b64 s[16:17], s[16:17], 1
    s_cmp_eq_u32 s30, 1
    s_cbranch_scc1 L_fin
    s_waitcnt vmcnt(5)
    v_mfma_f32_4x4x4_16b_bf16 v[180:183], v[248:249], v[64:65], 0
    v_mfma_f32_4x4x4_16b_bf16 v[184:187], v[248:249], v[66:67], 0
    s_add_u32 m0, s57, 16384
    s_nop 0
    buffer_load_dwordx4 v50, s[20:23], 0 offen nt lds
    s_nop 0
    v_mul_f32 v180, v180, v92
    v_mul_f32 v181, v181, v93
    v_mul_f32 v182, v182, v94
    v_mul_f32 v183, v183, v95
    v_mul_f32 v184, v184, v96
    v_mul_f32 v185, v185, v97
    v_mul_f32 v186, v186, v98
    v_mul_f32 v187, v187, v99
    v_cvt_pk_bf16_f32 v188, v180, v181
    v_cvt_pk_bf16_f32 v189, v182, v183
    v_cvt_pk_bf16_f32 v190, v184, v185
    v_cvt_pk_bf16_f32 v191, v186, v187
    ds_write_b128 v36, v[188:191] offset:36608
    s_mov_b64 exec, s[16:17]
    s_waitcnt vmcnt(5)
    ds_write_b16 v21, v17 offset:17920
    s_mov_b64 exec, -1
    s_lshl_b64 s[16:17], s[16:17], 1
    s_setprio 0
    s_cmp_eq_u32 s30, 2
    s_cbranch_scc1 L_fin
    ds_read_i16 v13, v32 offset:18560
    s_waitcnt vmcnt(4)
    s_setprio 2
    v_mfma_f32_4x4x4_16b_bf16 v[180:183], v[248:249], v[68:69], 0
    v_mfma_f32_4x4x4_16b_bf16 v[184:187], v[248:249], v[70:71], 0
    s_setprio 0
    s_add_u32 m0, s57, 20480
    s_nop 0
    buffer_load_dwordx4 v51, s[20:23], 0 offen nt lds
    v_mul_f32 v180, v180, v100
    v_mul_f32 v181, v181, v101
    v_mul_f32 v182, v182, v102
    v_mul_f32 v183, v183, v103
    v_mul_f32 v184, v184, v104
    v_mul_f32 v185, v185, v105
    v_mul_f32 v186, v186, v106
    v_mul_f32 v187, v187, v107
    v_cvt_pk_bf16_f32 v188, v180, v181
    v_cvt_pk_bf16_f32 v189, v182, v183
    v_cvt_pk_bf16_f32 v190, v184, v185
    v_cvt_pk_bf16_f32 v191, v186, v187
    s_waitcnt lgkmcnt(0)
    v_cmp_gt_i32 vcc, 0, v13
    ds_write_b128 v36, v[188:191] offset:40704
    s_mov_b64 exec, s[16:17]
    s_waitcnt vmcnt(4)
    ds_write_b16 v21, v17 offset:17920
    s_mov_b64 exec, -1
    s_lshl_b64 s[16:17], s[16:17], 1
    s_cmp_eq_u32 s30, 3
    s_cbranch_scc1 L_fin
    s_cbranch_vccz L_pok
L_pwait:
    ds_read_i16 v13, v32 offset:18560
    s_sub_u32 s56, s56, 1
    s_cbranch_scc1 L_exit
    s_waitcnt lgkmcnt(0)
    v_cmp_gt_i32 vcc, 0, v13
    s_cbranch_vccnz L_pwait
L_pok:
    s_waitcnt vmcnt(3)
    s_setprio 2
    v_mfma_f32_4x4x4_16b_bf16 v[180:183], v[248:249], v[72:73], 0
    v_mfma_f32_4x4x4_16b_bf16 v[184:187], v[248:249], v[74:75], 0
    s_setprio 0
    s_add_u32 m0, s57, 24576
    s_nop 0
    buffer_load_dwordx4 v52, s[20:23], 0 offen nt lds
    v_mul_f32 v180, v180, v108
    v_mul_f32 v181, v181, v109
    v_mul_f32 v182, v182, v110
    v_mul_f32 v183, v183, v111
    v_mul_f32 v184, v184, v112
    v_mul_f32 v185, v185, v113
    v_mul_f32 v186, v186, v114
    v_mul_f32 v187, v187, v115
    v_cvt_pk_bf16_f32 v188, v180, v181
    v_cvt_pk_bf16_f32 v189, v182, v183
    v_cvt_pk_bf16_f32 v190, v184, v185
    v_cvt_pk_bf16_f32 v191, v186, v187
    ds_write_b128 v36, v[188:191] offset:44800
    s_mov_b64 exec, s[16:17]
    s_waitcnt vmcnt(3)
    ds_write_b16 v21, v17 offset:17920
    s_mov_b64 exec, -1
    s_lshl_b64 s[16:17], s[16:17], 1
    s_cmp_eq_u32 s30, 4
    s_cbranch_scc1 L_fin
    s_waitcnt vmcnt(2)
    ds_read_b128 v[76:79], v254 offset:16384
    s_waitcnt lgkmcnt(0)
    s_setprio 2
    v_mfma_f32_4x4x4_16b_bf16 v[180:183], v[248:249], v[76:77], 0
    v_mfma_f32_4x4x4_16b_bf16 v[184:187], v[248:249], v[78:79], 0
    s_setprio 0
    s_add_u32 m0, s57, 28672
    s_nop 0
    buffer_load_dwordx4 v53, s[20:23], 0 offen nt lds
    v_mul_f32 v180, v180, v116
    v_mul_f32 v181, v181, v117
    v_mul_f32 v182, v182, v118
    v_mul_f32 v183, v183, v119
    v_mul_f32 v184, v184, v120
    v_mul_f32 v185, v185, v121
    v_mul_f32 v186, v186, v122
    v_mul_f32 v187, v187, v123
    v_cvt_pk_bf16_f32 v188, v180, v181
    v_cvt_pk_bf16_f32 v189, v182, v183
    v_cvt_pk_bf16_f32 v190, v184, v185
    v_cvt_pk_bf16_f32 v191, v186, v187
    ds_write_b128 v37, v[188:191] offset:8192
    s_mov_b64 exec, s[16:17]
    ds_write_b16 v21, v17 offset:17920
    s_mov_b64 exec, -1
    s_lshl_b64 s[16:17], s[16:17], 1
    s_cmp_eq_u32 s30, 5
    s_cbranch_scc1 L_fin
    s_waitcnt vmcnt(2)
    ds_read_b128 v[80:83], v254 offset:20480
    s_waitcnt lgkmcnt(0)
    s_setprio 2
    v_mfma_f32_4x4x4_16b_bf16 v[180:183], v[248:249], v[80:81], 0
    v_mfma_f32_4x4x4_16b_bf16 v[184:187], v[248:249], v[82:83], 0
    s_setprio 0
    s_add_u32 m0, s57, 32768
    s_nop 0
    buffer_load_dwordx4 v54, s[20:23], 0 offen nt lds
    v_mul_f32 v180, v180, v124
    v_mul_f32 v181, v181, v125
    v_mul_f32 v182, v182, v126
    v_mul_f32 v183, v183, v127
    v_mul_f32 v184, v184, v128
    v_mul_f32 v185, v185, v129
    v_mul_f32 v186, v186, v130
    v_mul_f32 v187, v187, v131
    v_cvt_pk_bf16_f32 v188, v180, v181
    v_cvt_pk_bf16_f32 v189, v182, v183
    v_cvt_pk_bf16_f32 v190, v184, v185
    v_cvt_pk_bf16_f32 v191, v186, v187
    s_waitcnt vmcnt(2)
    ds_read_b128 v[60:63], v254 offset:24576
    ds_write_b128 v37, v[188:191] offset:12288
    s_mov_b64 exec, s[16:17]
    ds_write_b16 v21, v17 offset:17920
    s_mov_b64 exec, -1
    s_lshl_b64 s[16:17], s[16:17], 1
    s_cmp_eq_u32 s30, 6
    s_cbranch_scc1 L_fin
    s_waitcnt lgkmcnt(2)
    s_setprio 2
    v_mfma_f32_4x4x4_16b_bf16 v[180:183], v[248:249], v[60:61], 0
    v_mfma_f32_4x4x4_16b_bf16 v[184:187], v[248:249], v[62:63], 0
    s_setprio 0
    s_add_u32 m0, s57, 36864
    s_nop 0
    buffer_load_dwordx4 v55, s[20:23], 0 offen nt lds
    v_mul_f32 v180, v180, v132
    v_mul_f32 v181, v181, v133
    v_mul_f32 v182, v182, v134
    v_mul_f32 v183, v183, v135
    v_mul_f32 v184, v184, v136
    v_mul_f32 v185, v185, v137
    v_mul_f32 v186, v186, v138
    v_mul_f32 v187, v187, v139
    v_cvt_pk_bf16_f32 v188, v180, v181
    v_cvt_pk_bf16_f32 v189, v182, v183
    v_cvt_pk_bf16_f32 v190, v184, v185
    v_cvt_pk_bf16_f32 v191, v186, v187
    s_waitcnt vmcnt(2)
    ds_read_b128 v[64:67], v254 offset:28672
    ds_write_b128 v37, v[188:191] offset:16384
    s_mov_b64 exec, s[16:17]
    ds_write_b16 v21, v17 offset:17920
    s_mov_b64 exec, -1
    s_lshl_b64 s[16:17], s[16:17], 1
    s_cmp_eq_u32 s30, 7
    s_cbranch_scc1 L_fin
    s_waitcnt lgkmcnt(2)
    s_setprio 2
    v_mfma_f32_4x4x4_16b_bf16 v[180:183], v[248:249], v[64:65], 0
    v_mfma_f32_4x4x4_16b_bf16 v[184:187], v[248:249], v[66:67], 0
    s_setprio 0
    s_add_u32 m0, s57, 40960
    s_nop 0
    buffer_load_dwordx4 v56, s[20:23], 0 offen nt lds
    v_mul_f32 v180, v180, v140
    v_mul_f32 v181, v181, v141
    v_mul_f32 v182, v182, v142
    v_mul_f32 v183, v183, v143
    v_mul_f32 v184, v184, v144
    v_mul_f32 v185, v185, v145
    v_mul_f32 v186, v186, v146
    v_mul_f32 v187, v187, v147
    v_cvt_pk_bf16_f32 v188, v180, v181
    v_cvt_pk_bf16_f32 v189, v182, v183
    v_cvt_pk_bf16_f32 v190, v184, v185
    v_cvt_pk_bf16_f32 v191, v186, v187
    s_waitcnt vmcnt(2)
    ds_read_b128 v[68:71], v254 offset:32768
    ds_write_b128 v37, v[188:191] offset:20480
    s_mov_b64 exec, s[16:17]
    ds_write_b16 v21, v17 offset:17920
    s_mov_b64 exec, -1
    s_lshl_b64 s[16:17], s[16:17], 1
    s_cmp_eq_u32 s30, 8
    s_cbranch_scc1 L_fin
    s_waitcnt lgkmcnt(2)
    s_setprio 2
    v_mfma_f32_4x4x4_16b_bf16 v[180:183], v[248:249], v[68:69], 0
    v_mfma_f32_4x4x4_16b_bf16 v[184:187], v[248:249], v[70:71], 0
    s_setprio 0
    s_add_u32 m0, s57, 45056
    s_nop 0
    buffer_load_dwordx4 v57, s[20:23], 0 offen nt lds
    v_mul_f32 v180, v180, v148
    v_mul_f32 v181, v181, v149
    v_mul_f32 v182, v182, v150
    v_mul_f32 v183, v183, v151
    v_mul_f32 v184, v184, v152
    v_mul_f32 v185, v185, v153
    v_mul_f32 v186, v186, v154
    v_mul_f32 v187, v187, v155
    v_cvt_pk_bf16_f32 v188, v180, v181
    v_cvt_pk_bf16_f32 v189, v182, v183
    v_cvt_pk_bf16_f32 v190, v184, v185
    v_cvt_pk_bf16_f32 v191, v186, v187
    s_waitcnt vmcnt(2)
    ds_read_b128 v[72:75], v254 offset:36864
    ds_write_b128 v37, v[188:191] offset:24576
    s_mov_b64 exec, s[16:17]
    ds_write_b16 v21, v17 offset:17920
    s_mov_b64 exec, -1
    s_lshl_b64 s[16:17], s[16:17], 1
    s_cmp_eq_u32 s30, 9
    s_cbranch_scc1 L_fin
    s_cmp_gt_u32 s30, 12
    s_cbranch_scc1 L_long
    s_waitcnt lgkmcnt(2)
    s_setprio 2
    v_mfma_f32_4x4x4_16b_bf16 v[180:183], v[248:249], v[72:73], 0
    v_mfma_f32_4x4x4_16b_bf16 v[184:187], v[248:249], v[74:75], 0
    s_setprio 0
    s_nop 2
    v_mul_f32 v180, v180, v156
    v_mul_f32 v181, v181, v157
    v_mul_f32 v182, v182, v158
    v_mul_f32 v183, v183, v159
    v_mul_f32 v184, v184, v160
    v_mul_f32 v185, v185, v161
    v_mul_f32 v186, v186, v162
    v_mul_f32 v187, v187, v163
    v_cvt_pk_bf16_f32 v188, v180, v181
    v_cvt_pk_bf16_f32 v189, v182, v183
    v_cvt_pk_bf16_f32 v190, v184, v185
    v_cvt_pk_bf16_f32 v191, v186, v187
    s_waitcnt vmcnt(1)
    ds_read_b128 v[76:79], v254 offset:40960
    ds_write_b128 v37, v[188:191] offset:28672
    s_mov_b64 exec, s[16:17]
    ds_write_b16 v21, v17 offset:17920
    s_mov_b64 exec, -1
    s_lshl_b64 s[16:17], s[16:17], 1
    s_cmp_eq_u32 s30, 10
    s_cbranch_scc1 L_fin
    s_waitcnt lgkmcnt(2)
    s_setprio 2
    v_mfma_f32_4x4x4_16b_bf16 v[180:183], v[248:249], v[76:77], 0
    v_mfma_f32_4x4x4_16b_bf16 v[184:187], v[248:249], v[78:79], 0
    s_setprio 0
    s_nop 2
    v_mul_f32 v180, v180, v164
    v_mul_f32 v181, v181, v165
    v_mul_f32 v182, v182, v166
    v_mul_f32 v183, v183, v167
    v_mul_f32 v184, v184, v168
    v_mul_f32 v185, v185, v169
    v_mul_f32 v186, v186, v170
    v_mul_f32 v187, v187, v171
    v_cvt_pk_bf16_f32 v188, v180, v181
    v_cvt_pk_bf16_f32 v189, v182, v183
    v_cvt_pk_bf16_f32 v190, v184, v185
    v_cvt_pk_bf16_f32 v191, v186, v187
    s_waitcnt vmcnt(0)
    ds_read_b128 v[80:83], v254 offset:45056
    ds_write_b128 v37, v[188:191] offset:32768
    s_mov_b64 exec, s[16:17]
    ds_write_b16 v21, v17 offset:17920
    s_mov_b64 exec, -1
    s_lshl_b64 s[16:17], s[16:17], 1
    s_cmp_eq_u32 s30, 11
    s_cbranch_scc1 L_fin
    s_waitcnt lgkmcnt(2)
    s_setprio 2
    v_mfma_f32_4x4x4_16b_bf16 v[180:183], v[248:249], v[80:81], 0
    v_mfma_f32_4x4x4_16b_bf16 v[184:187], v[248:249], v[82:83], 0
    s_setprio 0
    s_nop 2
    v_mul_f32 v180, v180, v172
    v_mul_f32 v181, v181, v173
    v_mul_f32 v182, v182, v174
    v_mul_f32 v183, v183, v175
    v_mul_f32 v184, v184, v176
    v_mul_f32 v185, v185, v177
    v_mul_f32 v186, v186, v178
    v_mul_f32 v187, v187, v179
    v_cvt_pk_bf16_f32 v188, v180, v181
    v_cvt_pk_bf16_f32 v189, v182, v183
    v_cvt_pk_bf16_f32 v190, v184, v185
    v_cvt_pk_bf16_f32 v191, v186, v187
    ds_write_b128 v37, v[188:191] offset:36864
    s_mov_b64 exec, s[16:17]
    ds_write_b16 v21, v17 offset:17920
    s_mov_b64 exec, -1
    s_lshl_b64 s[16:17], s[16:17], 1
    s_branch L_fin
L_long:
    s_setprio 2
    v_xor_b32_dpp v180, v18, v20 row_newbcast:12 row_mask:0xf bank_mask:0xf
    v_xor_b32_dpp v181, v18, v20 row_newbcast:13 row_mask:0xf bank_mask:0xf
    ds_read_b128 v[200:203], v180 offset:8704
    ds_read_b128 v[204:207], v181 offset:8704
    s_call_b64 s[60:61], L_touch12
    s_waitcnt lgkmcnt(1)
    v_mfma_f32_4x4x4_16b_bf16 v[84:87], v[250:251], v[200:201], 0
    v_mfma_f32_4x4x4_16b_bf16 v[88:91], v[250:251], v[202:203], 0
    s_waitcnt lgkmcnt(0)
    v_mfma_f32_4x4x4_16b_bf16 v[92:95], v[250:251], v[204:205], 0
    v_mfma_f32_4x4x4_16b_bf16 v[96:99], v[250:251], v[206:207], 0
    s_setprio 2
    v_mfma_f32_4x4x4_16b_bf16 v[180:183], v[248:249], v[72:73], 0
    v_mfma_f32_4x4x4_16b_bf16 v[184:187], v[248:249], v[74:75], 0
    s_setprio 0
    s_add_u32 m0, s57, 49152
    s_nop 0
    buffer_load_dwordx4 v58, s[20:23], 0 offen nt lds
    v_mul_f32 v180, v180, v156
    v_mul_f32 v181, v181, v157
    v_mul_f32 v182, v182, v158
    v_mul_f32 v183, v183, v159
    v_mul_f32 v184, v184, v160
    v_mul_f32 v185, v185, v161
    v_mul_f32 v186, v186, v162
    v_mul_f32 v187, v187, v163
    v_cvt_pk_bf16_f32 v188, v180, v181
    v_cvt_pk_bf16_f32 v189, v182, v183
    v_cvt_pk_bf16_f32 v190, v184, v185
    v_cvt_pk_bf16_f32 v191, v186, v187
    s_waitcnt vmcnt(2)
    ds_read_b128 v[76:79], v254 offset:40960
    ds_write_b128 v37, v[188:191] offset:28672
    s_mov_b64 exec, s[16:17]
    ds_write_b16 v21, v17 offset:17920
    s_mov_b64 exec, -1
    s_lshl_b64 s[16:17], s[16:17], 1
    s_waitcnt lgkmcnt(2)
    s_setprio 2
    v_mfma_f32_4x4x4_16b_bf16 v[180:183], v[248:249], v[76:77], 0
    v_mfma_f32_4x4x4_16b_bf16 v[184:187], v[248:249], v[78:79], 0
    s_setprio 0
    s_add_u32 m0, s57, 53248
    s_nop 0
    buffer_load_dwordx4 v59, s[20:23], 0 offen nt lds
    v_mul_f32 v180, v180, v164
    v_mul_f32 v181, v181, v165
    v_mul_f32 v182, v182, v166
    v_mul_f32 v183, v183, v167
    v_mul_f32 v184, v184, v168
    v_mul_f32 v185, v185, v169
    v_mul_f32 v186, v186, v170
    v_mul_f32 v187, v187, v171
    v_cvt_pk_bf16_f32 v188, v180, v181
    v_cvt_pk_bf16_f32 v189, v182, v183
    v_cvt_pk_bf16_f32 v190, v184, v185
    v_cvt_pk_bf16_f32 v191, v186, v187
    s_waitcnt vmcnt(2)
    ds_read_b128 v[80:83], v254 offset:45056
    ds_write_b128 v37, v[188:191] offset:32768
    s_mov_b64 exec, s[16:17]
    ds_write_b16 v21, v17 offset:17920
    s_mov_b64 exec, -1
    s_lshl_b64 s[16:17], s[16:17], 1
    s_waitcnt lgkmcnt(2)
    s_setprio 2
    v_mfma_f32_4x4x4_16b_bf16 v[180:183], v[248:249], v[80:81], 0
    v_mfma_f32_4x4x4_16b_bf16 v[184:187], v[248:249], v[82:83], 0
    s_setprio 0
    s_nop 2
    v_mul_f32 v180, v180, v172
    v_mul_f32 v181, v181, v173
    v_mul_f32 v182, v182, v174
    v_mul_f32 v183, v183, v175
    v_mul_f32 v184, v184, v176
    v_mul_f32 v185, v185, v177
    v_mul_f32 v186, v186, v178
    v_mul_f32 v187, v187, v179
    v_cvt_pk_bf16_f32 v188, v180, v181
    v_cvt_pk_bf16_f32 v189, v182, v183
    v_cvt_pk_bf16_f32 v190, v184, v185
    v_cvt_pk_bf16_f32 v191, v186, v187
    s_waitcnt vmcnt(1)
    ds_read_b128 v[60:63], v37 offset:0
    ds_write_b128 v37, v[188:191] offset:36864
    s_mov_b64 exec, s[16:17]
    ds_write_b16 v21, v17 offset:17920
    s_mov_b64 exec, -1
    s_lshl_b64 s[16:17], s[16:17], 1
    s_waitcnt lgkmcnt(2)
    s_setprio 2
    v_mfma_f32_4x4x4_16b_bf16 v[180:183], v[248:249], v[60:61], 0
    v_mfma_f32_4x4x4_16b_bf16 v[184:187], v[248:249], v[62:63], 0
    s_setprio 0
    s_nop 2
    v_mul_f32 v180, v180, v84
    v_mul_f32 v181, v181, v85
    v_mul_f32 v182, v182, v86
    v_mul_f32 v183, v183, v87
    v_mul_f32 v184, v184, v88
    v_mul_f32 v185, v185, v89
    v_mul_f32 v186, v186, v90
    v_mul_f32 v187, v187, v91
    v_cvt_pk_bf16_f32 v188, v180, v181
    v_cvt_pk_bf16_f32 v189, v182, v183
    v_cvt_pk_bf16_f32 v190, v184, v185
    v_cvt_pk_bf16_f32 v191, v186, v187
    s_waitcnt vmcnt(0)
    ds_read_b128 v[64:67], v37 offset:4096
    ds_write_b128 v37, v[188:191] offset:40960
    s_mov_b64 exec, s[16:17]
    ds_write_b16 v21, v17 offset:17920
    s_mov_b64 exec, -1
    s_lshl_b64 s[16:17], s[16:17], 1
    s_cmp_eq_u32 s30, 13
    s_cbranch_scc1 L_fin
    s_waitcnt lgkmcnt(2)
    s_setprio 2
    v_mfma_f32_4x4x4_16b_bf16 v[180:183], v[248:249], v[64:65], 0
    v_mfma_f32_4x4x4_16b_bf16 v[184:187], v[248:249], v[66:67], 0
    s_setprio 0
    s_nop 2
    v_mul_f32 v180, v180, v92
    v_mul_f32 v181, v181, v93
    v_mul_f32 v182, v182, v94
    v_mul_f32 v183, v183, v95
    v_mul_f32 v184, v184, v96
    v_mul_f32 v185, v185, v97
    v_mul_f32 v186, v186, v98
    v_mul_f32 v187, v187, v99
    v_cvt_pk_bf16_f32 v188, v180, v181
    v_cvt_pk_bf16_f32 v189, v182, v183
    v_cvt_pk_bf16_f32 v190, v184, v185
    v_cvt_pk_bf16_f32 v191, v186, v187
    ds_write_b128 v37, v[188:191] offset:45056
    s_mov_b64 exec, s[16:17]
    ds_write_b16 v21, v17 offset:17920
    s_mov_b64 exec, -1
    s_lshl_b64 s[16:17], s[16:17], 1
    s_cmp_eq_u32 s30, 14
    s_cbranch_scc1 L_fin
    v_add_u32 v15, 224, v15
    v_add_u32 v26, 448, v26
    v_add_u32 v21, 448, v21
    s_lshr_b64 s[16:17], s[16:17], 14
    v_subrev_u32 v180, s55, v15
    v_mov_b32 v182, s32
    v_mov_b32 v183, s33
    v_mov_b32 v184, 0
    v_mov_b32 v181, v180
    v_cmp_gt_u32 s[58:59], s54, v180
    v_cmpx_le_u32 vcc, s50, v180
    v_mov_b32 v182, s34
    v_mov_b32 v183, s35
    v_subrev_u32 v181, s50, v180
    v_mov_b32 v184, 64
    v_cmpx_le_u32 vcc, s51, v180
    v_mov_b32 v182, s36
    v_mov_b32 v183, s37
    v_subrev_u32 v181, s51, v180
    v_mov_b32 v184, 128
    v_cmpx_le_u32 vcc, s52, v180
    v_mov_b32 v182, s38
    v_mov_b32 v183, s39
    v_subrev_u32 v181, s52, v180
    v_mov_b32 v184, 192
    v_cmpx_le_u32 vcc, s53, v180
    v_mov_b32 v182, s40
    v_mov_b32 v183, s41
    v_subrev_u32 v181, s53, v180
    v_mov_b32 v184, 256
    s_mov_b64 exec, -1
    v_bcnt_u32_b32 v185, v182, 0
    v_cmpx_le_u32 vcc, v185, v181
    v_sub_u32 v181, v181, v185
    v_mov_b32 v182, v183
    v_add_u32 v184, 32, v184
    s_mov_b64 exec, -1
    v_and_b32 v185, 65535, v182
    v_bcnt_u32_b32 v185, v185, 0
    v_cmpx_le_u32 vcc, v185, v181
    v_sub_u32 v181, v181, v185
    v_lshrrev_b32 v182, 16, v182
    v_add_u32 v184, 16, v184
    s_mov_b64 exec, -1
    v_and_b32 v185, 255, v182
    v_bcnt_u32_b32 v185, v185, 0
    v_cmpx_le_u32 vcc, v185, v181
    v_sub_u32 v181, v181, v185
    v_lshrrev_b32 v182, 8, v182
    v_add_u32 v184, 8, v184
    s_mov_b64 exec, -1
    v_and_b32 v185, 15, v182
    v_bcnt_u32_b32 v185, v185, 0
    v_cmpx_le_u32 vcc, v185, v181
    v_sub_u32 v181, v181, v185
    v_lshrrev_b32 v182, 4, v182
    v_add_u32 v184, 4, v184
    s_mov_b64 exec, -1
    v_and_b32 v185, 3, v182
    v_bcnt_u32_b32 v185, v185, 0
    v_cmpx_le_u32 vcc, v185, v181
    v_sub_u32 v181, v181, v185
    v_lshrrev_b32 v182, 2, v182
    v_add_u32 v184, 2, v184
    s_mov_b64 exec, -1
    v_and_b32 v185, 1, v182
    v_cmpx_le_u32 vcc, v185, v181
    v_add_u32 v184, 1, v184
    s_mov_b64 exec, -1
    v_mul_u32_u24 v17, 3277, v184
    v_lshl_add_u32 v16, v184, 8, s28
    v_mov_b32 v180, 0x7fffff00
    v_lshrrev_b32 v17, 16, v17
    v_cndmask_b32 v16, v180, v16, s[58:59]
    v_mul_u32_u24 v18, 272, v17
    v_mul_u32_u24 v19, 656, v17
    v_mul_u32_u24 v17, 544, v17
    v_lshl_add_u32 v14, v184, 1, s42
    v_add_u32 v34, v19, v26
    global_load_ushort v35, v14, s[8:9]
    v_add_u32_dpp v46, v16, v20 row_newbcast:0 row_mask:0xf bank_mask:0xf
    v_add_u32_dpp v47, v16, v20 row_newbcast:1 row_mask:0xf bank_mask:0xf
    v_add_u32_dpp v48, v16, v20 row_newbcast:2 row_mask:0xf bank_mask:0xf
    v_add_u32_dpp v49, v16, v20 row_newbcast:3 row_mask:0xf bank_mask:0xf
    v_add_u32_dpp v50, v16, v20 row_newbcast:4 row_mask:0xf bank_mask:0xf
    v_add_u32_dpp v51, v16, v20 row_newbcast:5 row_mask:0xf bank_mask:0xf
    s_barrier
    s_add_u32 m0, s57, 57344
    s_nop 0
    buffer_load_dwordx4 v46, s[20:23], 0 offen nt lds
    s_add_u32 m0, s57, 61440
    s_nop 0
    buffer_load_dwordx4 v47, s[20:23], 0 offen nt lds
    s_add_u32 m0, s57, 65536
    s_nop 0
    buffer_load_dwordx4 v48, s[20:23], 0 offen nt lds
    s_add_u32 m0, s57, 69632
    s_nop 0
    buffer_load_dwordx4 v49, s[20:23], 0 offen nt lds
    s_add_u32 m0, s57, 73728
    s_nop 0
    buffer_load_dwordx4 v50, s[20:23], 0 offen nt lds
    s_add_u32 m0, s57, 77824
    s_nop 0
    buffer_load_dwordx4 v51, s[20:23], 0 offen nt lds
    v_xor_b32_dpp v180, v18, v20 row_newbcast:0 row_mask:0xf bank_mask:0xf
    v_xor_b32_dpp v181, v18, v20 row_newbcast:1 row_mask:0xf bank_mask:0xf
    v_xor_b32_dpp v182, v18, v20 row_newbcast:2 row_mask:0xf bank_mask:0xf
    v_xor_b32_dpp v183, v18, v20 row_newbcast:3 row_mask:0xf bank_mask:0xf
    v_xor_b32_dpp v184, v18, v20 row_newbcast:4 row_mask:0xf bank_mask:0xf
    v_xor_b32_dpp v185, v18, v20 row_newbcast:5 row_mask:0xf bank_mask:0xf
    ds_read_b128 v[200:203], v180 offset:8704
    ds_read_b128 v[204:207], v181 offset:8704
    ds_read_b128 v[208:211], v182 offset:8704
    ds_read_b128 v[212:215], v183 offset:8704
    ds_read_b128 v[216:219], v184 offset:8704
    ds_read_b128 v[220:223], v185 offset:8704
    s_waitcnt lgkmcnt(5)
    v_mfma_f32_4x4x4_16b_bf16 v[84:87], v[250:251], v[200:201], 0
    v_mfma_f32_4x4x4_16b_bf16 v[88:91], v[250:251], v[202:203], 0
    s_waitcnt lgkmcnt(4)
    v_mfma_f32_4x4x4_16b_bf16 v[92:95], v[250:251], v[204:205], 0
    v_mfma_f32_4x4x4_16b_bf16 v[96:99], v[250:251], v[206:207], 0
    s_waitcnt lgkmcnt(3)
    v_mfma_f32_4x4x4_16b_bf16 v[100:103], v[250:251], v[208:209], 0
    v_mfma_f32_4x4x4_16b_bf16 v[104:107], v[250:251], v[210:211], 0
    s_waitcnt lgkmcnt(2)
    v_mfma_f32_4x4x4_16b_bf16 v[108:111], v[250:251], v[212:213], 0
    v_mfma_f32_4x4x4_16b_bf16 v[112:115], v[250:251], v[214:215], 0
    s_waitcnt lgkmcnt(1)
    v_mfma_f32_4x4x4_16b_bf16 v[116:119], v[250:251], v[216:217], 0
    v_mfma_f32_4x4x4_16b_bf16 v[120:123], v[250:251], v[218:219], 0
    s_waitcnt lgkmcnt(0)
    v_mfma_f32_4x4x4_16b_bf16 v[124:127], v[250:251], v[220:221], 0
    v_mfma_f32_4x4x4_16b_bf16 v[128:131], v[250:251], v[222:223], 0
    s_waitcnt vmcnt(6)
    v_cndmask_b32 v35, 0, v35, s[58:59]
    v_lshrrev_b32 v12, 4, v0
    v_lshlrev_b32 v35, 16, v35
    v_mul_u32_u24 v12, 160, v12
    v_lshl_add_u32 v12, v2, 3, v12
    s_mov_b32 exec_lo, 0x003f003f
    s_mov_b32 exec_hi, 0x003f003f
    ds_write_b64 v12, v[34:35] offset:19056
    s_mov_b64 exec, -1
    s_waitcnt vmcnt(5)
    ds_read_b128 v[68:71], v37 offset:8192
    s_waitcnt lgkmcnt(0)
    s_setprio 2
    v_mfma_f32_4x4x4_16b_bf16 v[180:183], v[248:249], v[68:69], 0
    v_mfma_f32_4x4x4_16b_bf16 v[184:187], v[248:249], v[70:71], 0
    s_setprio 0
    s_nop 2
    v_mul_f32 v180, v180, v84
    v_mul_f32 v181, v181, v85
    v_mul_f32 v182, v182, v86
    v_mul_f32 v183, v183, v87
    v_mul_f32 v184, v184, v88
    v_mul_f32 v185, v185, v89
    v_mul_f32 v186, v186, v90
    v_mul_f32 v187, v187, v91
    v_cvt_pk_bf16_f32 v188, v180, v181
    v_cvt_pk_bf16_f32 v189, v182, v183
    v_cvt_pk_bf16_f32 v190, v184, v185
    v_cvt_pk_bf16_f32 v191, v186, v187
    s_waitcnt vmcnt(4)
    ds_read_b128 v[72:75], v37 offset:12288
    ds_write_b128 v36, v[188:191] offset:32512
    s_mov_b64 exec, s[16:17]
    ds_write_b16 v21, v17 offset:17920
    s_mov_b64 exec, -1
    s_lshl_b64 s[16:17], s[16:17], 1
    s_cmp_eq_u32 s30, 15
    s_cbranch_scc1 L_fin
    s_waitcnt lgkmcnt(2)
    s_setprio 2
    v_mfma_f32_4x4x4_16b_bf16 v[180:183], v[248:249], v[72:73], 0
    v_mfma_f32_4x4x4_16b_bf16 v[184:187], v[248:249], v[74:75], 0
    s_setprio 0
    s_nop 2
    v_mul_f32 v180, v180, v92
    v_mul_f32 v181, v181, v93
    v_mul_f32 v182, v182, v94
    v_mul_f32 v183, v183, v95
    v_mul_f32 v184, v184, v96
    v_mul_f32 v185, v185, v97
    v_mul_f32 v186, v186, v98
    v_mul_f32 v187, v187, v99
    v_cvt_pk_bf16_f32 v188, v180, v181
    v_cvt_pk_bf16_f32 v189, v182, v183
    v_cvt_pk_bf16_f32 v190, v184, v185
    v_cvt_pk_bf16_f32 v191, v186, v187
    s_waitcnt vmcnt(3)
    ds_read_b128 v[76:79], v37 offset:16384
    ds_write_b128 v36, v[188:191] offset:36608
    s_mov_b64 exec, s[16:17]
    ds_write_b16 v21, v17 offset:17920
    s_mov_b64 exec, -1
    s_lshl_b64 s[16:17], s[16:17], 1
    s_cmp_eq_u32 s30, 16
    s_cbranch_scc1 L_fin
    s_waitcnt lgkmcnt(2)
    s_setprio 2
    v_mfma_f32_4x4x4_16b_bf16 v[180:183], v[248:249], v[76:77], 0
    v_mfma_f32_4x4x4_16b_bf16 v[184:187], v[248:249], v[78:79], 0
    s_setprio 0
    s_nop 2
    v_mul_f32 v180, v180, v100
    v_mul_f32 v181, v181, v101
    v_mul_f32 v182, v182, v102
    v_mul_f32 v183, v183, v103
    v_mul_f32 v184, v184, v104
    v_mul_f32 v185, v185, v105
    v_mul_f32 v186, v186, v106
    v_mul_f32 v187, v187, v107
    v_cvt_pk_bf16_f32 v188, v180, v181
    v_cvt_pk_bf16_f32 v189, v182, v183
    v_cvt_pk_bf16_f32 v190, v184, v185
    v_cvt_pk_bf16_f32 v191, v186, v187
    s_waitcnt vmcnt(2)
    ds_read_b128 v[80:83], v37 offset:20480
    ds_write_b128 v36, v[188:191] offset:40704
    s_mov_b64 exec, s[16:17]
    ds_write_b16 v21, v17 offset:17920
    s_mov_b64 exec, -1
    s_lshl_b64 s[16:17], s[16:17], 1
    s_cmp_eq_u32 s30, 17
    s_cbranch_scc1 L_fin
    s_waitcnt lgkmcnt(2)
    s_setprio 2
    v_mfma_f32_4x4x4_16b_bf16 v[180:183], v[248:249], v[80:81], 0
    v_mfma_f32_4x4x4_16b_bf16 v[184:187], v[248:249], v[82:83], 0
    s_setprio 0
    s_nop 2
    v_mul_f32 v180, v180, v108
    v_mul_f32 v181, v181, v109
    v_mul_f32 v182, v182, v110
    v_mul_f32 v183, v183, v111
    v_mul_f32 v184, v184, v112
    v_mul_f32 v185, v185, v113
    v_mul_f32 v186, v186, v114
    v_mul_f32 v187, v187, v115
    v_cvt_pk_bf16_f32 v188, v180, v181
    v_cvt_pk_bf16_f32 v189, v182, v183
    v_cvt_pk_bf16_f32 v190, v184, v185
    v_cvt_pk_bf16_f32 v191, v186, v187
    s_waitcnt vmcnt(1)
    ds_read_b128 v[60:63], v37 offset:24576
    ds_write_b128 v36, v[188:191] offset:44800
    s_mov_b64 exec, s[16:17]
    ds_write_b16 v21, v17 offset:17920
    s_mov_b64 exec, -1
    s_lshl_b64 s[16:17], s[16:17], 1
    s_cmp_eq_u32 s30, 18
    s_cbranch_scc1 L_fin
    s_waitcnt lgkmcnt(2)
    s_setprio 2
    v_mfma_f32_4x4x4_16b_bf16 v[180:183], v[248:249], v[60:61], 0
    v_mfma_f32_4x4x4_16b_bf16 v[184:187], v[248:249], v[62:63], 0
    s_setprio 0
    s_nop 2
    v_mul_f32 v180, v180, v116
    v_mul_f32 v181, v181, v117
    v_mul_f32 v182, v182, v118
    v_mul_f32 v183, v183, v119
    v_mul_f32 v184, v184, v120
    v_mul_f32 v185, v185, v121
    v_mul_f32 v186, v186, v122
    v_mul_f32 v187, v187, v123
    v_cvt_pk_bf16_f32 v188, v180, v181
    v_cvt_pk_bf16_f32 v189, v182, v183
    v_cvt_pk_bf16_f32 v190, v184, v185
    v_cvt_pk_bf16_f32 v191, v186, v187
    s_waitcnt vmcnt(0)
    ds_read_b128 v[64:67], v37 offset:28672
    ds_write_b128 v37, v[188:191] offset:32768
    s_mov_b64 exec, s[16:17]
    ds_write_b16 v21, v17 offset:17920
    s_mov_b64 exec, -1
    s_lshl_b64 s[16:17], s[16:17], 1
    s_cmp_eq_u32 s30, 19
    s_cbranch_scc1 L_fin
    s_waitcnt lgkmcnt(2)
    s_setprio 2
    v_mfma_f32_4x4x4_16b_bf16 v[180:183], v[248:249], v[64:65], 0
    v_mfma_f32_4x4x4_16b_bf16 v[184:187], v[248:249], v[66:67], 0
    s_setprio 0
    s_nop 2
    v_mul_f32 v180, v180, v124
    v_mul_f32 v181, v181, v125
    v_mul_f32 v182, v182, v126
    v_mul_f32 v183, v183, v127
    v_mul_f32 v184, v184, v128
    v_mul_f32 v185, v185, v129
    v_mul_f32 v186, v186, v130
    v_mul_f32 v187, v187, v131
    v_cvt_pk_bf16_f32 v188, v180, v181
    v_cvt_pk_bf16_f32 v189, v182, v183
    v_cvt_pk_bf16_f32 v190, v184, v185
    v_cvt_pk_bf16_f32 v191, v186, v187
    ds_write_b128 v37, v[188:191] offset:36864
    s_mov_b64 exec, s[16:17]
    ds_write_b16 v21, v17 offset:17920
    s_mov_b64 exec, -1
    s_lshl_b64 s[16:17], s[16:17], 1
    s_branch L_fin
L_exit:
L_end:
    s_endpgm
.section .rodata,"a"
.p2align 6
.amdhsa_kernel standalone__sequential_behavior_din__recsys_kernel
  .amdhsa_next_free_vgpr 256
  .amdhsa_next_free_sgpr 80
  .amdhsa_accum_offset 256
  .amdhsa_group_segment_fixed_size 0
  .amdhsa_kernarg_size 80
  .amdhsa_user_sgpr_count 2
  .amdhsa_user_sgpr_kernarg_segment_ptr 1
  .amdhsa_system_sgpr_workgroup_id_x 1
  .amdhsa_float_denorm_mode_32 3
.end_amdhsa_kernel
```
